```python
import torch

def _softmax(x, axis=-1):
    return torch.softmax(x, dim=axis)
def _gelu(x):
    return torch.nn.functional.gelu(x, approximate="tanh")
def _silu(x):
    return torch.nn.functional.silu(x)
def _sigmoid(x):
    return torch.sigmoid(x)
def _layernorm(x, axis=-1, eps=1e-5):
    m = x.mean(dim=axis, keepdim=True)
    v = x.var(dim=axis, keepdim=True, unbiased=False)
    return (x - m) / torch.sqrt(v + eps)
def _scatter_add(tgt, idx, src, axis=0):
    return tgt.clone().index_add_(axis, idx, src)
def _segment_sum(src, seg, n):
    out = torch.zeros((n,) + src.shape[1:], dtype=src.dtype)
    return out.index_add_(0, seg, src)
def _pad(x, pw):
    flat = tuple(v for pair in reversed(pw) for v in pair)
    return torch.nn.functional.pad(x, flat)

kernel_name = 'sequential_preLN__sliding_block__glu_gated_swiglu__prompt'

def setup_inputs():

    _w = (lambda a: (lambda t: t.to(torch.bfloat16) if t.is_floating_point() else t)(torch.as_tensor(a)))
    def _A_setup():
        B, S, D = 1, 2048, 1024
        return {
            "x": _w((lambda *s: torch.randn(*s, dtype=torch.bfloat16) * 0.05)(B, S, D)),
            "wqkv": _w((lambda *s: torch.randn(*s, dtype=torch.bfloat16) * 0.05)(D, 3 * D)),
            "wo": _w((lambda *s: torch.randn(*s, dtype=torch.bfloat16) * 0.05)(D, D)),
        }
    _A_in = _A_setup()

    def _B_setup():
        B, S, D, F = 1, 2048, 1024, 3584
        return {
            "x": _w((lambda *s: torch.randn(*s, dtype=torch.bfloat16) * 0.05)(B, S, D)),
            "w1": _w((lambda *s: torch.randn(*s, dtype=torch.bfloat16) * 0.8)(D, F) * (2.0 / D) ** 0.5),
            "w3": _w((lambda *s: torch.randn(*s, dtype=torch.bfloat16) * 0.8)(D, F) * (2.0 / D) ** 0.5),
            "w2": _w((lambda *s: torch.randn(*s, dtype=torch.bfloat16) * 0.8)(F, D) * (2.0 / F) ** 0.5),
        }
    _B_in = _B_setup()

    return {
        "A_x": _A_in["x"],
        "A_wqkv": _A_in["wqkv"],
        "A_wo": _A_in["wo"],
        "B_x": _B_in["x"],
        "B_w1": _B_in["w1"],
        "B_w3": _B_in["w3"],
        "B_w2": _B_in["w2"],
    }

def reference(A_x, A_wqkv, A_wo, B_x, B_w1, B_w3, B_w2):
    def _A_ref(x, wqkv, wo):
        B, S, D = x.shape
        H = 32; Dh = D // H; W = 256
        qkv = (lambda x, *d: x.permute(*d))((x @ wqkv).reshape(B, S, 3, H, Dh), 2, 0, 3, 1, 4)
        q, k, v = qkv[0], qkv[1], qkv[2]
        scores = torch.einsum("bhqd,bhkd->bhqk", q, k) * (Dh ** -0.5)
        idx = torch.arange(S)
        mask = (idx[:, None] - idx[None, :] >= 0) & (idx[:, None] - idx[None, :] < W)
        scores = torch.where(mask[None, None], scores, -1e9)
        p = _softmax(scores, axis=-1)
        o = torch.einsum("bhqk,bhkd->bhqd", p, v)
        return (lambda x, *d: x.permute(*d))(o, 0, 2, 1, 3).reshape(B, S, D) @ wo

    def _B_ref(x, w1, w3, w2):
        gate = torch.einsum("bsd,df->bsf", x, w1)
        up = torch.einsum("bsd,df->bsf", x, w3)
        h = _silu(gate) * up
        out = torch.einsum("bsf,fd->bsd", h, w2)
        return out

    x = A_x
    h = x + _A_ref(_layernorm(x, axis=-1), A_wqkv, A_wo)
    h2 = h + _B_ref(_layernorm(h, axis=-1), B_w1, B_w3, B_w2)
    return h2
```

```asm
; @launch kernel=g1_kernel grid=(256,1,1) block=(512,1,1) lds=163840
; @launch kernel=attn_kernel grid=(656,1,1) block=(256,1,1) lds=49152
; @launch kernel=g2_kernel grid=(256,1,1) block=(512,1,1) lds=147456
; @launch kernel=g3_kernel grid=(256,1,1) block=(512,1,1) lds=135168
; @launch kernel=g4_kernel grid=(256,1,1) block=(512,1,1) lds=147456
.amdgcn_target "amdgcn-amd-amdhsa--gfx950"
.text
.globl g1_kernel
.p2align 8
.type g1_kernel,@function
g1_kernel:
    s_cmp_ge_u32 s2, 256
    s_cbranch_scc1 g1_kernel_end
    s_load_dwordx16 s[64:79], s[0:1], 0
    s_load_dwordx4 s[80:83], s[0:1], 64
    s_waitcnt lgkmcnt(0)
    s_mov_b32 s4, s64
    s_and_b32 s5, s65, 0xffff
    s_mov_b32 s6, 4194304
    s_mov_b32 s7, 0x00020000
    s_mov_b32 s8, s66
    s_and_b32 s9, s67, 0xffff
    s_mov_b32 s10, 6291456
    s_mov_b32 s11, 0x00020000
    s_add_u32 s12, s66, 256
    s_addc_u32 s13, s67, 0
    s_and_b32 s13, s13, 0xffff
    s_mov_b32 s14, 6291200
    s_mov_b32 s15, 0x00020000
    s_and_b32 s25, s2, 7
    s_lshr_b32 s26, s2, 3
    s_and_b32 s20, s25, 3
    s_mul_i32 s20, s20, 4
    s_and_b32 s27, s26, 3
    s_add_u32 s20, s20, s27
    s_lshr_b32 s21, s25, 2
    s_mul_i32 s21, s21, 8
    s_lshr_b32 s27, s26, 2
    s_add_u32 s21, s21, s27
    v_lshrrev_b32 v1, 6, v0
    s_nop 0
    v_readfirstlane_b32 s19, v1
    s_and_b32 s23, s19, 1
    s_lshr_b32 s24, s19, 1
    s_and_b32 s24, s24, 1
    s_sub_u32 s22, s19, 4
    s_and_b32 s22, s22, 3
    v_and_b32 v0, 63, v0
    v_lshrrev_b32 v1, 3, v0
    v_and_b32 v64, 7, v0
    v_xor_b32 v64, v64, v1
    v_lshlrev_b32 v64, 4, v64
    s_mul_i32 s25, s22, 32
    s_mul_i32 s26, s20, 128
    s_add_u32 s25, s25, s26
    v_add_u32 v1, s25, v1
    s_mov_b32 s26, 2048
    v_mul_lo_u32 v1, v1, s26
    v_add_u32 v2, v1, v64
    v_add_u32 v3, 16384, v2
    v_add_u32 v4, 32768, v2
    v_add_u32 v5, 49152, v2
    s_mul_i32 s25, s22, 16
    s_add_u32 s25, s25, 0
    v_lshrrev_b32 v1, 4, v0
    v_add_u32 v1, s25, v1
    v_and_b32 v64, 3, v1
    v_lshrrev_b32 v65, 1, v1
    v_and_b32 v65, 4, v65
    v_or_b32 v64, v64, v65
    v_lshlrev_b32 v64, 1, v64
    v_and_b32 v65, 15, v0
    v_xor_b32 v64, v64, v65
    v_lshlrev_b32 v64, 4, v64
    s_mov_b32 s26, 6144
    v_mul_lo_u32 v1, v1, s26
    v_add_u32 v1, v1, v64
    s_mul_i32 s26, s21, 384
    v_add_u32 v6, s26, v1
    s_mul_i32 s25, s22, 16
    s_add_u32 s25, s25, 4
    v_lshrrev_b32 v1, 4, v0
    v_add_u32 v1, s25, v1
    v_and_b32 v64, 3, v1
    v_lshrrev_b32 v65, 1, v1
    v_and_b32 v65, 4, v65
    v_or_b32 v64, v64, v65
    v_lshlrev_b32 v64, 1, v64
    v_and_b32 v65, 15, v0
    v_xor_b32 v64, v64, v65
    v_lshlrev_b32 v64, 4, v64
    s_mov_b32 s26, 6144
    v_mul_lo_u32 v1, v1, s26
    v_add_u32 v1, v1, v64
    s_mul_i32 s26, s21, 384
    v_add_u32 v7, s26, v1
    s_mul_i32 s25, s22, 16
    s_add_u32 s25, s25, 8
    v_lshrrev_b32 v1, 4, v0
    v_add_u32 v1, s25, v1
    v_and_b32 v64, 3, v1
    v_lshrrev_b32 v65, 1, v1
    v_and_b32 v65, 4, v65
    v_or_b32 v64, v64, v65
    v_lshlrev_b32 v64, 1, v64
    v_and_b32 v65, 15, v0
    v_xor_b32 v64, v64, v65
    v_lshlrev_b32 v64, 4, v64
    s_mov_b32 s26, 6144
    v_mul_lo_u32 v1, v1, s26
    v_add_u32 v1, v1, v64
    s_mul_i32 s26, s21, 384
    v_add_u32 v8, s26, v1
    s_mul_i32 s25, s22, 16
    s_add_u32 s25, s25, 12
    v_lshrrev_b32 v1, 4, v0
    v_add_u32 v1, s25, v1
    v_and_b32 v64, 3, v1
    v_lshrrev_b32 v65, 1, v1
    v_and_b32 v65, 4, v65
    v_or_b32 v64, v64, v65
    v_lshlrev_b32 v64, 1, v64
    v_and_b32 v65, 15, v0
    v_xor_b32 v64, v64, v65
    v_lshlrev_b32 v64, 4, v64
    s_mov_b32 s26, 6144
    v_mul_lo_u32 v1, v1, s26
    v_add_u32 v1, v1, v64
    s_mul_i32 s26, s21, 384
    v_add_u32 v9, s26, v1
    s_mul_i32 s25, s22, 16
    s_add_u32 s25, s25, 0
    v_lshrrev_b32 v1, 3, v0
    v_add_u32 v1, s25, v1
    v_bfe_u32 v64, v1, 1, 1
    v_lshrrev_b32 v65, 2, v1
    v_and_b32 v65, 2, v65
    v_or_b32 v64, v64, v65
    v_lshlrev_b32 v64, 1, v64
    v_and_b32 v65, 7, v0
    v_xor_b32 v64, v64, v65
    v_lshlrev_b32 v64, 4, v64
    s_mov_b32 s26, 6144
    v_mul_lo_u32 v1, v1, s26
    v_add_u32 v1, v1, v64
    s_mul_i32 s26, s21, 384
    v_add_u32 v10, s26, v1
    s_mul_i32 s25, s22, 16
    s_add_u32 s25, s25, 8
    v_lshrrev_b32 v1, 3, v0
    v_add_u32 v1, s25, v1
    v_bfe_u32 v64, v1, 1, 1
    v_lshrrev_b32 v65, 2, v1
    v_and_b32 v65, 2, v65
    v_or_b32 v64, v64, v65
    v_lshlrev_b32 v64, 1, v64
    v_and_b32 v65, 7, v0
    v_xor_b32 v64, v64, v65
    v_lshlrev_b32 v64, 4, v64
    s_mov_b32 s26, 6144
    v_mul_lo_u32 v1, v1, s26
    v_add_u32 v1, v1, v64
    s_mul_i32 s26, s21, 384
    v_add_u32 v11, s26, v1
    s_mov_b32 s30, 0
    s_mov_b32 s31, 0
    s_mov_b32 s32, 0
    s_mov_b32 s34, 0
    s_mul_i32 s35, s22, 4096
    s_mul_i32 s44, s22, 4096
    s_add_u32 s44, s44, 16384
    s_mul_i32 s45, s22, 2048
    s_add_u32 s45, s45, 32768
    s_mov_b32 s37, 0
    s_cmp_lt_u32 s19, 4
    s_cbranch_scc1 g1_kernel_comp
    s_add_u32 s36, s34, s35
    s_mov_b32 m0, s36
    s_nop 0
    buffer_load_dwordx4 v2, s[4:7], s30 offen lds
    s_add_u32 m0, s36, 1024
    s_nop 0
    buffer_load_dwordx4 v3, s[4:7], s30 offen lds
    s_add_u32 m0, s36, 2048
    s_nop 0
    buffer_load_dwordx4 v4, s[4:7], s30 offen lds
    s_add_u32 m0, s36, 3072
    s_nop 0
    buffer_load_dwordx4 v5, s[4:7], s30 offen lds
    s_add_u32 s36, s34, s44
    s_mov_b32 m0, s36
    s_nop 0
    buffer_load_dwordx4 v6, s[8:11], s31 offen lds
    s_add_u32 m0, s36, 1024
    s_nop 0
    buffer_load_dwordx4 v7, s[8:11], s31 offen lds
    s_add_u32 m0, s36, 2048
    s_nop 0
    buffer_load_dwordx4 v8, s[8:11], s31 offen lds
    s_add_u32 m0, s36, 3072
    s_nop 0
    buffer_load_dwordx4 v9, s[8:11], s31 offen lds
    s_add_u32 s36, s34, s45
    s_mov_b32 m0, s36
    s_nop 0
    buffer_load_dwordx4 v10, s[12:15], s32 offen lds
    s_add_u32 m0, s36, 1024
    s_nop 0
    buffer_load_dwordx4 v11, s[12:15], s32 offen lds
    s_add_u32 s30, s30, 128
    s_add_u32 s31, s31, 393216
    s_add_u32 s32, s32, 393216
    s_add_u32 s34, s34, 40960
    s_cmp_eq_u32 s34, 163840
    s_cselect_b32 s34, 0, s34
    s_add_u32 s36, s34, s35
    s_mov_b32 m0, s36
    s_nop 0
    buffer_load_dwordx4 v2, s[4:7], s30 offen lds
    s_add_u32 m0, s36, 1024
    s_nop 0
    buffer_load_dwordx4 v3, s[4:7], s30 offen lds
    s_add_u32 m0, s36, 2048
    s_nop 0
    buffer_load_dwordx4 v4, s[4:7], s30 offen lds
    s_add_u32 m0, s36, 3072
    s_nop 0
    buffer_load_dwordx4 v5, s[4:7], s30 offen lds
    s_add_u32 s36, s34, s44
    s_mov_b32 m0, s36
    s_nop 0
    buffer_load_dwordx4 v6, s[8:11], s31 offen lds
    s_add_u32 m0, s36, 1024
    s_nop 0
    buffer_load_dwordx4 v7, s[8:11], s31 offen lds
    s_add_u32 m0, s36, 2048
    s_nop 0
    buffer_load_dwordx4 v8, s[8:11], s31 offen lds
    s_add_u32 m0, s36, 3072
    s_nop 0
    buffer_load_dwordx4 v9, s[8:11], s31 offen lds
    s_add_u32 s36, s34, s45
    s_mov_b32 m0, s36
    s_nop 0
    buffer_load_dwordx4 v10, s[12:15], s32 offen lds
    s_add_u32 m0, s36, 1024
    s_nop 0
    buffer_load_dwordx4 v11, s[12:15], s32 offen lds
    s_add_u32 s30, s30, 128
    s_add_u32 s31, s31, 393216
    s_add_u32 s32, s32, 393216
    s_add_u32 s34, s34, 40960
    s_cmp_eq_u32 s34, 163840
    s_cselect_b32 s34, 0, s34
    s_add_u32 s36, s34, s35
    s_mov_b32 m0, s36
    s_nop 0
    buffer_load_dwordx4 v2, s[4:7], s30 offen lds
    s_add_u32 m0, s36, 1024
    s_nop 0
    buffer_load_dwordx4 v3, s[4:7], s30 offen lds
    s_add_u32 m0, s36, 2048
    s_nop 0
    buffer_load_dwordx4 v4, s[4:7], s30 offen lds
    s_add_u32 m0, s36, 3072
    s_nop 0
    buffer_load_dwordx4 v5, s[4:7], s30 offen lds
    s_add_u32 s36, s34, s44
    s_mov_b32 m0, s36
    s_nop 0
    buffer_load_dwordx4 v6, s[8:11], s31 offen lds
    s_add_u32 m0, s36, 1024
    s_nop 0
    buffer_load_dwordx4 v7, s[8:11], s31 offen lds
    s_add_u32 m0, s36, 2048
    s_nop 0
    buffer_load_dwordx4 v8, s[8:11], s31 offen lds
    s_add_u32 m0, s36, 3072
    s_nop 0
    buffer_load_dwordx4 v9, s[8:11], s31 offen lds
    s_add_u32 s36, s34, s45
    s_mov_b32 m0, s36
    s_nop 0
    buffer_load_dwordx4 v10, s[12:15], s32 offen lds
    s_add_u32 m0, s36, 1024
    s_nop 0
    buffer_load_dwordx4 v11, s[12:15], s32 offen lds
    s_add_u32 s30, s30, 128
    s_add_u32 s31, s31, 393216
    s_add_u32 s32, s32, 393216
    s_add_u32 s34, s34, 40960
    s_cmp_eq_u32 s34, 163840
    s_cselect_b32 s34, 0, s34
    v_lshrrev_b32 v86, 1, v0
    s_lshl_b32 s25, s22, 5
    v_add_u32 v87, s25, v86
    v_lshlrev_b32 v87, 7, v87
    v_and_b32 v88, 1, v0
    v_lshlrev_b32 v88, 6, v88
    v_add_u32 v87, v87, v88
    v_lshrrev_b32 v86, 1, v86
    v_add_u32 v88, 0, v86
    v_and_b32 v88, 3, v88
    v_lshlrev_b32 v88, 4, v88
    v_add_u32 v90, v87, v88
    v_add_u32 v88, 1, v86
    v_and_b32 v88, 3, v88
    v_lshlrev_b32 v88, 4, v88
    v_add_u32 v91, v87, v88
    v_add_u32 v88, 2, v86
    v_and_b32 v88, 3, v88
    v_lshlrev_b32 v88, 4, v88
    v_add_u32 v92, v87, v88
    v_add_u32 v88, 3, v86
    v_and_b32 v88, 3, v88
    v_lshlrev_b32 v88, 4, v88
    v_add_u32 v93, v87, v88
    v_mov_b32 v84, 0
    v_mov_b32 v85, 0
    v_mov_b32 v36, 0x3f803f80
    s_mov_b32 s39, 0
    s_waitcnt vmcnt(20)
    s_barrier
    v_add_u32 v64, s39, v90
    v_add_u32 v65, s39, v91
    v_add_u32 v66, s39, v92
    v_add_u32 v67, s39, v93
    ds_read_b128 v[68:71], v64
    ds_read_b128 v[72:75], v65
    ds_read_b128 v[76:79], v66
    ds_read_b128 v[80:83], v67
    s_add_u32 s39, s39, 40960
    s_cmp_eq_u32 s39, 163840
    s_cselect_b32 s39, 0, s39
    s_waitcnt lgkmcnt(3)
    v_dot2c_f32_bf16 v84, v68, v36
    v_dot2c_f32_bf16 v85, v68, v68
    v_dot2c_f32_bf16 v84, v69, v36
    v_dot2c_f32_bf16 v85, v69, v69
    v_dot2c_f32_bf16 v84, v70, v36
    v_dot2c_f32_bf16 v85, v70, v70
    v_dot2c_f32_bf16 v84, v71, v36
    v_dot2c_f32_bf16 v85, v71, v71
    s_waitcnt lgkmcnt(2)
    v_dot2c_f32_bf16 v84, v72, v36
    v_dot2c_f32_bf16 v85, v72, v72
    v_dot2c_f32_bf16 v84, v73, v36
    v_dot2c_f32_bf16 v85, v73, v73
    v_dot2c_f32_bf16 v84, v74, v36
    v_dot2c_f32_bf16 v85, v74, v74
    v_dot2c_f32_bf16 v84, v75, v36
    v_dot2c_f32_bf16 v85, v75, v75
    s_waitcnt lgkmcnt(1)
    v_dot2c_f32_bf16 v84, v76, v36
    v_dot2c_f32_bf16 v85, v76, v76
    v_dot2c_f32_bf16 v84, v77, v36
    v_dot2c_f32_bf16 v85, v77, v77
    v_dot2c_f32_bf16 v84, v78, v36
    v_dot2c_f32_bf16 v85, v78, v78
    v_dot2c_f32_bf16 v84, v79, v36
    v_dot2c_f32_bf16 v85, v79, v79
    s_waitcnt lgkmcnt(0)
    v_dot2c_f32_bf16 v84, v80, v36
    v_dot2c_f32_bf16 v85, v80, v80
    v_dot2c_f32_bf16 v84, v81, v36
    v_dot2c_f32_bf16 v85, v81, v81
    v_dot2c_f32_bf16 v84, v82, v36
    v_dot2c_f32_bf16 v85, v82, v82
    v_dot2c_f32_bf16 v84, v83, v36
    v_dot2c_f32_bf16 v85, v83, v83
g1_kernel_lloop:
    s_waitcnt vmcnt(10)
    s_barrier
    s_add_u32 s36, s34, s35
    s_mov_b32 m0, s36
    s_nop 0
    buffer_load_dwordx4 v2, s[4:7], s30 offen lds
    s_add_u32 m0, s36, 1024
    s_nop 0
    buffer_load_dwordx4 v3, s[4:7], s30 offen lds
    s_add_u32 m0, s36, 2048
    s_nop 0
    buffer_load_dwordx4 v4, s[4:7], s30 offen lds
    s_add_u32 m0, s36, 3072
    s_nop 0
    buffer_load_dwordx4 v5, s[4:7], s30 offen lds
    s_add_u32 s36, s34, s44
    s_mov_b32 m0, s36
    s_nop 0
    buffer_load_dwordx4 v6, s[8:11], s31 offen lds
    s_add_u32 m0, s36, 1024
    s_nop 0
    buffer_load_dwordx4 v7, s[8:11], s31 offen lds
    s_add_u32 m0, s36, 2048
    s_nop 0
    buffer_load_dwordx4 v8, s[8:11], s31 offen lds
    s_add_u32 m0, s36, 3072
    s_nop 0
    buffer_load_dwordx4 v9, s[8:11], s31 offen lds
    s_add_u32 s36, s34, s45
    s_mov_b32 m0, s36
    s_nop 0
    buffer_load_dwordx4 v10, s[12:15], s32 offen lds
    s_add_u32 m0, s36, 1024
    s_nop 0
    buffer_load_dwordx4 v11, s[12:15], s32 offen lds
    s_add_u32 s30, s30, 128
    s_add_u32 s31, s31, 393216
    s_add_u32 s32, s32, 393216
    s_add_u32 s34, s34, 40960
    s_cmp_eq_u32 s34, 163840
    s_cselect_b32 s34, 0, s34
    s_add_u32 s37, s37, 1
    s_cmp_lt_u32 s37, 16
    s_cbranch_scc0 g1_kernel_ldone
    v_add_u32 v64, s39, v90
    v_add_u32 v65, s39, v91
    v_add_u32 v66, s39, v92
    v_add_u32 v67, s39, v93
    ds_read_b128 v[68:71], v64
    ds_read_b128 v[72:75], v65
    ds_read_b128 v[76:79], v66
    ds_read_b128 v[80:83], v67
    s_add_u32 s39, s39, 40960
    s_cmp_eq_u32 s39, 163840
    s_cselect_b32 s39, 0, s39
    s_waitcnt lgkmcnt(3)
    v_dot2c_f32_bf16 v84, v68, v36
    v_dot2c_f32_bf16 v85, v68, v68
    v_dot2c_f32_bf16 v84, v69, v36
    v_dot2c_f32_bf16 v85, v69, v69
    v_dot2c_f32_bf16 v84, v70, v36
    v_dot2c_f32_bf16 v85, v70, v70
    v_dot2c_f32_bf16 v84, v71, v36
    v_dot2c_f32_bf16 v85, v71, v71
    s_waitcnt lgkmcnt(2)
    v_dot2c_f32_bf16 v84, v72, v36
    v_dot2c_f32_bf16 v85, v72, v72
    v_dot2c_f32_bf16 v84, v73, v36
    v_dot2c_f32_bf16 v85, v73, v73
    v_dot2c_f32_bf16 v84, v74, v36
    v_dot2c_f32_bf16 v85, v74, v74
    v_dot2c_f32_bf16 v84, v75, v36
    v_dot2c_f32_bf16 v85, v75, v75
    s_waitcnt lgkmcnt(1)
    v_dot2c_f32_bf16 v84, v76, v36
    v_dot2c_f32_bf16 v85, v76, v76
    v_dot2c_f32_bf16 v84, v77, v36
    v_dot2c_f32_bf16 v85, v77, v77
    v_dot2c_f32_bf16 v84, v78, v36
    v_dot2c_f32_bf16 v85, v78, v78
    v_dot2c_f32_bf16 v84, v79, v36
    v_dot2c_f32_bf16 v85, v79, v79
    s_waitcnt lgkmcnt(0)
    v_dot2c_f32_bf16 v84, v80, v36
    v_dot2c_f32_bf16 v85, v80, v80
    v_dot2c_f32_bf16 v84, v81, v36
    v_dot2c_f32_bf16 v85, v81, v81
    v_dot2c_f32_bf16 v84, v82, v36
    v_dot2c_f32_bf16 v85, v82, v82
    v_dot2c_f32_bf16 v84, v83, v36
    v_dot2c_f32_bf16 v85, v83, v83
    s_branch g1_kernel_lloop
g1_kernel_ldone:
    s_waitcnt vmcnt(0)
    ds_swizzle_b32 v86, v84 offset:0x041F
    s_waitcnt lgkmcnt(0)
    v_add_f32 v84, v84, v86
    ds_swizzle_b32 v86, v85 offset:0x041F
    s_waitcnt lgkmcnt(0)
    v_add_f32 v85, v85, v86
    s_barrier
    v_lshrrev_b32 v86, 1, v0
    s_lshl_b32 s25, s22, 5
    v_add_u32 v86, s25, v86
    v_lshlrev_b32 v86, 3, v86
    ds_write_b64 v86, v[84:85]
    s_waitcnt lgkmcnt(0)
    s_barrier
    s_endpgm
g1_kernel_comp:
    v_and_b32 v1, 15, v0
    v_lshlrev_b32 v1, 7, v1
    v_lshrrev_b32 v64, 4, v0
    v_and_b32 v65, 7, v0
    s_mul_i32 s25, s23, 8192
    v_add_u32 v1, s25, v1
    v_xor_b32 v66, v64, v65
    v_lshlrev_b32 v66, 4, v66
    v_add_u32 v12, v1, v66
    v_or_b32 v64, 4, v64
    v_xor_b32 v66, v64, v65
    v_lshlrev_b32 v66, 4, v66
    v_add_u32 v13, v1, v66
    v_lshrrev_b32 v1, 4, v0
    v_lshlrev_b32 v1, 3, v1
    v_bfe_u32 v64, v0, 2, 2
    v_add_u32 v1, v1, v64
    v_bfe_u32 v65, v0, 4, 1
    v_lshlrev_b32 v65, 2, v65
    v_or_b32 v65, v65, v64
    s_mul_i32 s25, s24, 4
    s_add_u32 s25, s25, 0
    v_xor_b32 v65, s25, v65
    v_lshlrev_b32 v65, 5, v65
    s_mov_b32 s26, 256
    v_mul_lo_u32 v1, v1, s26
    v_and_b32 v66, 3, v0
    v_lshlrev_b32 v66, 3, v66
    v_add3_u32 v14, v1, v65, v66
    v_lshrrev_b32 v1, 4, v0
    v_lshlrev_b32 v1, 3, v1
    v_bfe_u32 v64, v0, 2, 2
    v_add_u32 v1, v1, v64
    v_bfe_u32 v65, v0, 4, 1
    v_lshlrev_b32 v65, 2, v65
    v_or_b32 v65, v65, v64
    s_mul_i32 s25, s24, 4
    s_add_u32 s25, s25, 1
    v_xor_b32 v65, s25, v65
    v_lshlrev_b32 v65, 5, v65
    s_mov_b32 s26, 256
    v_mul_lo_u32 v1, v1, s26
    v_and_b32 v66, 3, v0
    v_lshlrev_b32 v66, 3, v66
    v_add3_u32 v15, v1, v65, v66
    v_lshrrev_b32 v1, 4, v0
    v_lshlrev_b32 v1, 3, v1
    v_bfe_u32 v64, v0, 2, 2
    v_add_u32 v1, v1, v64
    v_bfe_u32 v65, v0, 4, 1
    v_lshlrev_b32 v65, 2, v65
    v_or_b32 v65, v65, v64
    s_mul_i32 s25, s24, 4
    s_add_u32 s25, s25, 2
    v_xor_b32 v65, s25, v65
    v_lshlrev_b32 v65, 5, v65
    s_mov_b32 s26, 256
    v_mul_lo_u32 v1, v1, s26
    v_and_b32 v66, 3, v0
    v_lshlrev_b32 v66, 3, v66
    v_add3_u32 v16, v1, v65, v66
    v_lshrrev_b32 v1, 4, v0
    v_lshlrev_b32 v1, 3, v1
    v_bfe_u32 v64, v0, 2, 2
    v_add_u32 v1, v1, v64
    v_bfe_u32 v65, v0, 4, 1
    v_lshlrev_b32 v65, 2, v65
    v_or_b32 v65, v65, v64
    s_mul_i32 s25, s24, 4
    s_add_u32 s25, s25, 3
    v_xor_b32 v65, s25, v65
    v_lshlrev_b32 v65, 5, v65
    s_mov_b32 s26, 256
    v_mul_lo_u32 v1, v1, s26
    v_and_b32 v66, 3, v0
    v_lshlrev_b32 v66, 3, v66
    v_add3_u32 v17, v1, v65, v66
    v_lshrrev_b32 v1, 4, v0
    v_lshlrev_b32 v1, 3, v1
    v_bfe_u32 v64, v0, 2, 2
    v_add_u32 v1, v1, v64
    v_bfe_u32 v65, v0, 3, 1
    v_bfe_u32 v66, v0, 4, 1
    v_lshlrev_b32 v66, 1, v66
    v_or_b32 v65, v65, v66
    s_mul_i32 s25, s24, 2
    s_add_u32 s25, s25, 0
    v_xor_b32 v65, s25, v65
    v_lshlrev_b32 v65, 5, v65
    s_mov_b32 s26, 128
    v_mul_lo_u32 v1, v1, s26
    v_and_b32 v66, 3, v0
    v_lshlrev_b32 v66, 3, v66
    v_add3_u32 v18, v1, v65, v66
    v_lshrrev_b32 v1, 4, v0
    v_lshlrev_b32 v1, 3, v1
    v_bfe_u32 v64, v0, 2, 2
    v_add_u32 v1, v1, v64
    v_bfe_u32 v65, v0, 3, 1
    v_bfe_u32 v66, v0, 4, 1
    v_lshlrev_b32 v66, 1, v66
    v_or_b32 v65, v65, v66
    s_mul_i32 s25, s24, 2
    s_add_u32 s25, s25, 1
    v_xor_b32 v65, s25, v65
    v_lshlrev_b32 v65, 5, v65
    s_mov_b32 s26, 128
    v_mul_lo_u32 v1, v1, s26
    v_and_b32 v66, 3, v0
    v_lshlrev_b32 v66, 3, v66
    v_add3_u32 v19, v1, v65, v66
    v_mov_b32 v144, 0
    v_mov_b32 v145, 0
    v_mov_b32 v146, 0
    v_mov_b32 v147, 0
    v_mov_b32 v148, 0
    v_mov_b32 v149, 0
    v_mov_b32 v150, 0
    v_mov_b32 v151, 0
    v_mov_b32 v152, 0
    v_mov_b32 v153, 0
    v_mov_b32 v154, 0
    v_mov_b32 v155, 0
    v_mov_b32 v156, 0
    v_mov_b32 v157, 0
    v_mov_b32 v158, 0
    v_mov_b32 v159, 0
    v_mov_b32 v160, 0
    v_mov_b32 v161, 0
    v_mov_b32 v162, 0
    v_mov_b32 v163, 0
    v_mov_b32 v164, 0
    v_mov_b32 v165, 0
    v_mov_b32 v166, 0
    v_mov_b32 v167, 0
    v_mov_b32 v168, 0
    v_mov_b32 v169, 0
    v_mov_b32 v170, 0
    v_mov_b32 v171, 0
    v_mov_b32 v172, 0
    v_mov_b32 v173, 0
    v_mov_b32 v174, 0
    v_mov_b32 v175, 0
    v_mov_b32 v176, 0
    v_mov_b32 v177, 0
    v_mov_b32 v178, 0
    v_mov_b32 v179, 0
    v_mov_b32 v180, 0
    v_mov_b32 v181, 0
    v_mov_b32 v182, 0
    v_mov_b32 v183, 0
    v_mov_b32 v184, 0
    v_mov_b32 v185, 0
    v_mov_b32 v186, 0
    v_mov_b32 v187, 0
    v_mov_b32 v188, 0
    v_mov_b32 v189, 0
    v_mov_b32 v190, 0
    v_mov_b32 v191, 0
    v_mov_b32 v192, 0
    v_mov_b32 v193, 0
    v_mov_b32 v194, 0
    v_mov_b32 v195, 0
    v_mov_b32 v196, 0
    v_mov_b32 v197, 0
    v_mov_b32 v198, 0
    v_mov_b32 v199, 0
    v_mov_b32 v200, 0
    v_mov_b32 v201, 0
    v_mov_b32 v202, 0
    v_mov_b32 v203, 0
    v_mov_b32 v204, 0
    v_mov_b32 v205, 0
    v_mov_b32 v206, 0
    v_mov_b32 v207, 0
    v_mov_b32 v208, 0
    v_mov_b32 v209, 0
    v_mov_b32 v210, 0
    v_mov_b32 v211, 0
    v_mov_b32 v212, 0
    v_mov_b32 v213, 0
    v_mov_b32 v214, 0
    v_mov_b32 v215, 0
    v_mov_b32 v216, 0
    v_mov_b32 v217, 0
    v_mov_b32 v218, 0
    v_mov_b32 v219, 0
    v_mov_b32 v220, 0
    v_mov_b32 v221, 0
    v_mov_b32 v222, 0
    v_mov_b32 v223, 0
    v_mov_b32 v224, 0
    v_mov_b32 v225, 0
    v_mov_b32 v226, 0
    v_mov_b32 v227, 0
    v_mov_b32 v228, 0
    v_mov_b32 v229, 0
    v_mov_b32 v230, 0
    v_mov_b32 v231, 0
    v_mov_b32 v232, 0
    v_mov_b32 v233, 0
    v_mov_b32 v234, 0
    v_mov_b32 v235, 0
    v_mov_b32 v236, 0
    v_mov_b32 v237, 0
    v_mov_b32 v238, 0
    v_mov_b32 v239, 0
    v_mov_b32 v28, 0
    v_mov_b32 v29, 0
    v_mov_b32 v30, 0
    v_mov_b32 v31, 0
    v_mov_b32 v32, 0
    v_mov_b32 v33, 0
    v_mov_b32 v34, 0
    v_mov_b32 v35, 0
    v_mov_b32 v36, 0x3f803f80
    v_mov_b32 v37, 0x3f803f80
    v_mov_b32 v38, 0x3f803f80
    v_mov_b32 v39, 0x3f803f80
    v_mov_b32 v40, 0
    v_mov_b32 v41, 0
    v_mov_b32 v42, 0
    v_mov_b32 v43, 0
    v_mov_b32 v44, 0
    v_mov_b32 v45, 0
    v_mov_b32 v46, 0
    v_mov_b32 v47, 0
    v_mov_b32 v48, 0
    v_mov_b32 v49, 0
    v_mov_b32 v50, 0
    v_mov_b32 v51, 0
    v_mov_b32 v52, 0
    v_mov_b32 v53, 0
    v_mov_b32 v54, 0
    v_mov_b32 v55, 0
    v_mov_b32 v56, 0
    v_mov_b32 v57, 0
    v_mov_b32 v58, 0
    v_mov_b32 v59, 0
    v_mov_b32 v60, 0
    v_mov_b32 v61, 0
    v_mov_b32 v62, 0
    v_mov_b32 v63, 0
    s_mov_b32 s38, 0
    v_add_u32 v20, s38, v12
    v_add_u32 v21, s38, v13
    v_add_u32 v22, s38, v14
    v_add_u32 v23, s38, v15
    v_add_u32 v24, s38, v16
    v_add_u32 v25, s38, v17
    v_add_u32 v26, s38, v18
    v_add_u32 v27, s38, v19
    s_add_u32 s38, s38, 40960
    s_cmp_eq_u32 s38, 163840
    s_cselect_b32 s38, 0, s38
    s_barrier
    ds_read_b128 v[64:67], v20 offset:0
    ds_read_b128 v[68:71], v20 offset:2048
    ds_read_b128 v[72:75], v20 offset:4096
    ds_read_b128 v[76:79], v20 offset:6144
    ds_read_b64_tr_b16 v[96:97], v22 offset:16384
    ds_read_b64_tr_b16 v[98:99], v22 offset:17408
    ds_read_b64_tr_b16 v[100:101], v23 offset:16384
    ds_read_b64_tr_b16 v[102:103], v23 offset:17408
    ds_read_b64_tr_b16 v[104:105], v24 offset:16384
    ds_read_b64_tr_b16 v[106:107], v24 offset:17408
    ds_read_b64_tr_b16 v[108:109], v25 offset:16384
    ds_read_b64_tr_b16 v[110:111], v25 offset:17408
    ds_read_b64_tr_b16 v[112:113], v26 offset:32768
    ds_read_b64_tr_b16 v[114:115], v26 offset:33280
    ds_read_b64_tr_b16 v[116:117], v27 offset:32768
    ds_read_b64_tr_b16 v[118:119], v27 offset:33280
g1_kernel_loop:
    s_waitcnt lgkmcnt(0)
    v_mfma_f32_16x16x32_bf16 v[144:147], v[96:99], v[64:67], v[144:147]
    ds_read_b128 v[80:83], v21 offset:0
    v_mfma_f32_16x16x32_bf16 v[148:151], v[100:103], v[64:67], v[148:151]
    ds_read_b128 v[84:87], v21 offset:2048
    v_mfma_f32_16x16x32_bf16 v[152:155], v[104:107], v[64:67], v[152:155]
    ds_read_b128 v[88:91], v21 offset:4096
    v_mfma_f32_16x16x32_bf16 v[156:159], v[108:111], v[64:67], v[156:159]
    ds_read_b128 v[92:95], v21 offset:6144
    v_mfma_f32_16x16x32_bf16 v[160:163], v[112:115], v[64:67], v[160:163]
    ds_read_b64_tr_b16 v[120:121], v22 offset:24576
    v_mfma_f32_16x16x32_bf16 v[164:167], v[116:119], v[64:67], v[164:167]
    ds_read_b64_tr_b16 v[122:123], v22 offset:25600
    v_mfma_f32_16x16x32_bf16 v[168:171], v[96:99], v[68:71], v[168:171]
    ds_read_b64_tr_b16 v[124:125], v23 offset:24576
    v_mfma_f32_16x16x32_bf16 v[172:175], v[100:103], v[68:71], v[172:175]
    ds_read_b64_tr_b16 v[126:127], v23 offset:25600
    v_mfma_f32_16x16x32_bf16 v[176:179], v[104:107], v[68:71], v[176:179]
    ds_read_b64_tr_b16 v[128:129], v24 offset:24576
    v_mfma_f32_16x16x32_bf16 v[180:183], v[108:111], v[68:71], v[180:183]
    ds_read_b64_tr_b16 v[130:131], v24 offset:25600
    v_mfma_f32_16x16x32_bf16 v[184:187], v[112:115], v[68:71], v[184:187]
    ds_read_b64_tr_b16 v[132:133], v25 offset:24576
    v_mfma_f32_16x16x32_bf16 v[188:191], v[116:119], v[68:71], v[188:191]
    ds_read_b64_tr_b16 v[134:135], v25 offset:25600
    v_mfma_f32_16x16x32_bf16 v[192:195], v[96:99], v[72:75], v[192:195]
    ds_read_b64_tr_b16 v[136:137], v26 offset:36864
    v_mfma_f32_16x16x32_bf16 v[196:199], v[100:103], v[72:75], v[196:199]
    ds_read_b64_tr_b16 v[138:139], v26 offset:37376
    v_mfma_f32_16x16x32_bf16 v[200:203], v[104:107], v[72:75], v[200:203]
    ds_read_b64_tr_b16 v[140:141], v27 offset:36864
    v_mfma_f32_16x16x32_bf16 v[204:207], v[108:111], v[72:75], v[204:207]
    ds_read_b64_tr_b16 v[142:143], v27 offset:37376
    v_mfma_f32_16x16x32_bf16 v[208:211], v[112:115], v[72:75], v[208:211]
    v_mfma_f32_16x16x32_bf16 v[212:215], v[116:119], v[72:75], v[212:215]
    v_mfma_f32_16x16x32_bf16 v[216:219], v[96:99], v[76:79], v[216:219]
    v_mfma_f32_16x16x32_bf16 v[220:223], v[100:103], v[76:79], v[220:223]
    v_mfma_f32_16x16x32_bf16 v[224:227], v[104:107], v[76:79], v[224:227]
    v_mfma_f32_16x16x32_bf16 v[228:231], v[108:111], v[76:79], v[228:231]
    v_mfma_f32_16x16x32_bf16 v[232:235], v[112:115], v[76:79], v[232:235]
    v_mfma_f32_16x16x32_bf16 v[236:239], v[116:119], v[76:79], v[236:239]
    v_mfma_f32_16x16x32_bf16 v[40:43], v[96:99], v[36:39], v[40:43]
    v_mfma_f32_16x16x32_bf16 v[44:47], v[100:103], v[36:39], v[44:47]
    v_mfma_f32_16x16x32_bf16 v[48:51], v[104:107], v[36:39], v[48:51]
    v_mfma_f32_16x16x32_bf16 v[52:55], v[108:111], v[36:39], v[52:55]
    v_mfma_f32_16x16x32_bf16 v[56:59], v[112:115], v[36:39], v[56:59]
    v_mfma_f32_16x16x32_bf16 v[60:63], v[116:119], v[36:39], v[60:63]
    s_barrier
    s_waitcnt lgkmcnt(0)
    v_mfma_f32_16x16x32_bf16 v[144:147], v[120:123], v[80:83], v[144:147]
    v_add_u32 v20, s38, v12
    v_mfma_f32_16x16x32_bf16 v[148:151], v[124:127], v[80:83], v[148:151]
    v_add_u32 v21, s38, v13
    v_mfma_f32_16x16x32_bf16 v[152:155], v[128:131], v[80:83], v[152:155]
    v_add_u32 v22, s38, v14
    v_mfma_f32_16x16x32_bf16 v[156:159], v[132:135], v[80:83], v[156:159]
    v_add_u32 v23, s38, v15
    v_mfma_f32_16x16x32_bf16 v[160:163], v[136:139], v[80:83], v[160:163]
    v_add_u32 v24, s38, v16
    v_mfma_f32_16x16x32_bf16 v[164:167], v[140:143], v[80:83], v[164:167]
    v_add_u32 v25, s38, v17
    v_mfma_f32_16x16x32_bf16 v[168:171], v[120:123], v[84:87], v[168:171]
    v_add_u32 v26, s38, v18
    v_mfma_f32_16x16x32_bf16 v[172:175], v[124:127], v[84:87], v[172:175]
    v_add_u32 v27, s38, v19
    s_add_u32 s38, s38, 40960
    s_cmp_eq_u32 s38, 163840
    s_cselect_b32 s38, 0, s38
    v_mfma_f32_16x16x32_bf16 v[176:179], v[128:131], v[84:87], v[176:179]
    ds_read_b128 v[64:67], v20 offset:0
    v_mfma_f32_16x16x32_bf16 v[180:183], v[132:135], v[84:87], v[180:183]
    ds_read_b128 v[68:71], v20 offset:2048
    v_mfma_f32_16x16x32_bf16 v[184:187], v[136:139], v[84:87], v[184:187]
    ds_read_b128 v[72:75], v20 offset:4096
    v_mfma_f32_16x16x32_bf16 v[188:191], v[140:143], v[84:87], v[188:191]
    ds_read_b128 v[76:79], v20 offset:6144
    v_mfma_f32_16x16x32_bf16 v[192:195], v[120:123], v[88:91], v[192:195]
    ds_read_b64_tr_b16 v[96:97], v22 offset:16384
    v_mfma_f32_16x16x32_bf16 v[196:199], v[124:127], v[88:91], v[196:199]
    ds_read_b64_tr_b16 v[98:99], v22 offset:17408
    v_mfma_f32_16x16x32_bf16 v[200:203], v[128:131], v[88:91], v[200:203]
    ds_read_b64_tr_b16 v[100:101], v23 offset:16384
    v_mfma_f32_16x16x32_bf16 v[204:207], v[132:135], v[88:91], v[204:207]
    ds_read_b64_tr_b16 v[102:103], v23 offset:17408
    v_mfma_f32_16x16x32_bf16 v[208:211], v[136:139], v[88:91], v[208:211]
    ds_read_b64_tr_b16 v[104:105], v24 offset:16384
    v_mfma_f32_16x16x32_bf16 v[212:215], v[140:143], v[88:91], v[212:215]
    ds_read_b64_tr_b16 v[106:107], v24 offset:17408
    v_mfma_f32_16x16x32_bf16 v[216:219], v[120:123], v[92:95], v[216:219]
    ds_read_b64_tr_b16 v[108:109], v25 offset:16384
    v_mfma_f32_16x16x32_bf16 v[220:223], v[124:127], v[92:95], v[220:223]
    ds_read_b64_tr_b16 v[110:111], v25 offset:17408
    v_mfma_f32_16x16x32_bf16 v[224:227], v[128:131], v[92:95], v[224:227]
    ds_read_b64_tr_b16 v[112:113], v26 offset:32768
    v_mfma_f32_16x16x32_bf16 v[228:231], v[132:135], v[92:95], v[228:231]
    ds_read_b64_tr_b16 v[114:115], v26 offset:33280
    v_mfma_f32_16x16x32_bf16 v[232:235], v[136:139], v[92:95], v[232:235]
    ds_read_b64_tr_b16 v[116:117], v27 offset:32768
    v_mfma_f32_16x16x32_bf16 v[236:239], v[140:143], v[92:95], v[236:239]
    ds_read_b64_tr_b16 v[118:119], v27 offset:33280
    v_mfma_f32_16x16x32_bf16 v[40:43], v[120:123], v[36:39], v[40:43]
    v_mfma_f32_16x16x32_bf16 v[44:47], v[124:127], v[36:39], v[44:47]
    v_mfma_f32_16x16x32_bf16 v[48:51], v[128:131], v[36:39], v[48:51]
    v_mfma_f32_16x16x32_bf16 v[52:55], v[132:135], v[36:39], v[52:55]
    v_mfma_f32_16x16x32_bf16 v[56:59], v[136:139], v[36:39], v[56:59]
    v_mfma_f32_16x16x32_bf16 v[60:63], v[140:143], v[36:39], v[60:63]
    s_add_u32 s37, s37, 1
    s_cmp_lt_u32 s37, 16
    s_cbranch_scc1 g1_kernel_loop
g1_kernel_done:
    s_waitcnt vmcnt(0) lgkmcnt(0)
    s_nop 7
    s_barrier
    s_barrier
    v_and_b32 v2, 15, v0
    s_mul_i32 s25, s23, 64
    v_add_u32 v2, s25, v2
    v_lshlrev_b32 v2, 3, v2
    ds_read_b32 v28, v2 offset:0
    ds_read_b32 v32, v2 offset:4
    ds_read_b32 v29, v2 offset:128
    ds_read_b32 v33, v2 offset:132
    ds_read_b32 v30, v2 offset:256
    ds_read_b32 v34, v2 offset:260
    ds_read_b32 v31, v2 offset:384
    ds_read_b32 v35, v2 offset:388
    s_waitcnt lgkmcnt(0)
    v_mul_f32 v28, 0x3a800000, v28
    v_mul_f32 v32, 0x3a800000, v32
    v_mul_f32 v29, 0x3a800000, v29
    v_mul_f32 v33, 0x3a800000, v33
    v_mul_f32 v30, 0x3a800000, v30
    v_mul_f32 v34, 0x3a800000, v34
    v_mul_f32 v31, 0x3a800000, v31
    v_mul_f32 v35, 0x3a800000, v35
    v_fma_f32 v32, -v28, v28, v32
    v_fma_f32 v33, -v29, v29, v33
    v_fma_f32 v34, -v30, v30, v34
    v_fma_f32 v35, -v31, v31, v35
    v_cvt_pk_bf16_f32 v2, v28, v32
    v_cvt_pk_bf16_f32 v3, v29, v33
    v_cvt_pk_bf16_f32 v4, v30, v34
    v_cvt_pk_bf16_f32 v5, v31, v35
    v_lshlrev_b32 v28, 16, v2
    v_and_b32 v32, 0xffff0000, v2
    v_lshlrev_b32 v29, 16, v3
    v_and_b32 v33, 0xffff0000, v3
    v_lshlrev_b32 v30, 16, v4
    v_and_b32 v34, 0xffff0000, v4
    v_lshlrev_b32 v31, 16, v5
    v_and_b32 v35, 0xffff0000, v5
    v_add_f32 v32, 0x3727c5ac, v32
    v_add_f32 v33, 0x3727c5ac, v33
    v_add_f32 v34, 0x3727c5ac, v34
    v_add_f32 v35, 0x3727c5ac, v35
    v_cvt_pk_bf16_f32 v2, v32, v32
    v_cvt_pk_bf16_f32 v3, v33, v33
    v_cvt_pk_bf16_f32 v4, v34, v34
    v_cvt_pk_bf16_f32 v5, v35, v35
    v_lshlrev_b32 v32, 16, v2
    v_lshlrev_b32 v33, 16, v3
    v_lshlrev_b32 v34, 16, v4
    v_lshlrev_b32 v35, 16, v5
    v_sqrt_f32 v32, v32
    v_sqrt_f32 v33, v33
    v_sqrt_f32 v34, v34
    v_sqrt_f32 v35, v35
    s_nop 0
    v_cvt_pk_bf16_f32 v2, v32, v32
    v_cvt_pk_bf16_f32 v3, v33, v33
    v_cvt_pk_bf16_f32 v4, v34, v34
    v_cvt_pk_bf16_f32 v5, v35, v35
    v_lshlrev_b32 v32, 16, v2
    v_lshlrev_b32 v33, 16, v3
    v_lshlrev_b32 v34, 16, v4
    v_lshlrev_b32 v35, 16, v5
    v_rcp_f32 v32, v32
    v_rcp_f32 v33, v33
    v_rcp_f32 v34, v34
    v_rcp_f32 v35, v35
    s_nop 0
    s_add_u32 s40, s82, 4194304
    s_addc_u32 s41, s83, 0
    s_and_b32 s41, s41, 0xffff
    s_mov_b32 s42, 12582912
    s_mov_b32 s43, 0x00020000
    s_barrier
    s_mul_i32 s27, s19, 12288
    v_and_b32 v64, 15, v0
    v_and_b32 v65, 7, v0
    v_bfe_u32 v66, v0, 5, 1
    v_or_b32 v66, 0, v66
    v_xor_b32 v65, v65, v66
    v_lshlrev_b32 v65, 4, v65
    v_mul_u32_u24 v64, 128, v64
    v_bfe_u32 v66, v0, 4, 1
    v_lshlrev_b32 v66, 3, v66
    v_add3_u32 v64, v64, v65, v66
    v_add_u32 v64, s27, v64
    v_and_b32 v65, 15, v0
    v_and_b32 v66, 7, v0
    v_bfe_u32 v67, v0, 5, 1
    v_or_b32 v67, 2, v67
    v_xor_b32 v66, v66, v67
    v_lshlrev_b32 v66, 4, v66
    v_mul_u32_u24 v65, 128, v65
    v_bfe_u32 v67, v0, 4, 1
    v_lshlrev_b32 v67, 3, v67
    v_add3_u32 v65, v65, v66, v67
    v_add_u32 v65, s27, v65
    v_and_b32 v66, 15, v0
    v_and_b32 v67, 7, v0
    v_bfe_u32 v68, v0, 5, 1
    v_or_b32 v68, 4, v68
    v_xor_b32 v67, v67, v68
    v_lshlrev_b32 v67, 4, v67
    v_mul_u32_u24 v66, 128, v66
    v_bfe_u32 v68, v0, 4, 1
    v_lshlrev_b32 v68, 3, v68
    v_add3_u32 v66, v66, v67, v68
    v_add_u32 v66, s27, v66
    v_and_b32 v67, 15, v0
    v_and_b32 v68, 7, v0
    v_bfe_u32 v69, v0, 5, 1
    v_or_b32 v69, 6, v69
    v_xor_b32 v68, v68, v69
    v_lshlrev_b32 v68, 4, v68
    v_mul_u32_u24 v67, 128, v67
    v_bfe_u32 v69, v0, 4, 1
    v_lshlrev_b32 v69, 3, v69
    v_add3_u32 v67, v67, v68, v69
    v_add_u32 v67, s27, v67
    v_and_b32 v68, 15, v0
    v_and_b32 v69, 3, v0
    v_bfe_u32 v70, v0, 5, 1
    v_or_b32 v70, 0, v70
    v_xor_b32 v69, v69, v70
    v_lshlrev_b32 v69, 4, v69
    v_mul_u32_u24 v68, 64, v68
    v_bfe_u32 v70, v0, 4, 1
    v_lshlrev_b32 v70, 3, v70
    v_add3_u32 v68, v68, v69, v70
    v_add_u32 v68, s27, v68
    v_and_b32 v69, 15, v0
    v_and_b32 v70, 3, v0
    v_bfe_u32 v71, v0, 5, 1
    v_or_b32 v71, 2, v71
    v_xor_b32 v70, v70, v71
    v_lshlrev_b32 v70, 4, v70
    v_mul_u32_u24 v69, 64, v69
    v_bfe_u32 v71, v0, 4, 1
    v_lshlrev_b32 v71, 3, v71
    v_add3_u32 v69, v69, v70, v71
    v_add_u32 v69, s27, v69
    v_fma_f32 v144, -v28, v40, v144
    v_fma_f32 v145, -v28, v41, v145
    v_fma_f32 v146, -v28, v42, v146
    v_fma_f32 v147, -v28, v43, v147
    v_mul_f32 v144, v144, v32
    v_mul_f32 v145, v145, v32
    v_mul_f32 v146, v146, v32
    v_mul_f32 v147, v147, v32
    v_cvt_pk_bf16_f32 v144, v144, v145
    v_cvt_pk_bf16_f32 v145, v146, v147
    ds_write_b64 v64, v[144:145] offset:0
    v_fma_f32 v168, -v29, v40, v168
    v_fma_f32 v169, -v29, v41, v169
    v_fma_f32 v170, -v29, v42, v170
    v_fma_f32 v171, -v29, v43, v171
    v_mul_f32 v168, v168, v33
    v_mul_f32 v169, v169, v33
    v_mul_f32 v170, v170, v33
    v_mul_f32 v171, v171, v33
    v_cvt_pk_bf16_f32 v168, v168, v169
    v_cvt_pk_bf16_f32 v169, v170, v171
    ds_write_b64 v64, v[168:169] offset:2048
    v_fma_f32 v192, -v30, v40, v192
    v_fma_f32 v193, -v30, v41, v193
    v_fma_f32 v194, -v30, v42, v194
    v_fma_f32 v195, -v30, v43, v195
    v_mul_f32 v192, v192, v34
    v_mul_f32 v193, v193, v34
    v_mul_f32 v194, v194, v34
    v_mul_f32 v195, v195, v34
    v_cvt_pk_bf16_f32 v192, v192, v193
    v_cvt_pk_bf16_f32 v193, v194, v195
    ds_write_b64 v64, v[192:193] offset:4096
    v_fma_f32 v216, -v31, v40, v216
    v_fma_f32 v217, -v31, v41, v217
    v_fma_f32 v218, -v31, v42, v218
    v_fma_f32 v219, -v31, v43, v219
    v_mul_f32 v216, v216, v35
    v_mul_f32 v217, v217, v35
    v_mul_f32 v218, v218, v35
    v_mul_f32 v219, v219, v35
    v_cvt_pk_bf16_f32 v216, v216, v217
    v_cvt_pk_bf16_f32 v217, v218, v219
    ds_write_b64 v64, v[216:217] offset:6144
    v_fma_f32 v148, -v28, v44, v148
    v_fma_f32 v149, -v28, v45, v149
    v_fma_f32 v150, -v28, v46, v150
    v_fma_f32 v151, -v28, v47, v151
    v_mul_f32 v148, v148, v32
    v_mul_f32 v149, v149, v32
    v_mul_f32 v150, v150, v32
    v_mul_f32 v151, v151, v32
    v_cvt_pk_bf16_f32 v148, v148, v149
    v_cvt_pk_bf16_f32 v149, v150, v151
    ds_write_b64 v65, v[148:149] offset:0
    v_fma_f32 v172, -v29, v44, v172
    v_fma_f32 v173, -v29, v45, v173
    v_fma_f32 v174, -v29, v46, v174
    v_fma_f32 v175, -v29, v47, v175
    v_mul_f32 v172, v172, v33
    v_mul_f32 v173, v173, v33
    v_mul_f32 v174, v174, v33
    v_mul_f32 v175, v175, v33
    v_cvt_pk_bf16_f32 v172, v172, v173
    v_cvt_pk_bf16_f32 v173, v174, v175
    ds_write_b64 v65, v[172:173] offset:2048
    v_fma_f32 v196, -v30, v44, v196
    v_fma_f32 v197, -v30, v45, v197
    v_fma_f32 v198, -v30, v46, v198
    v_fma_f32 v199, -v30, v47, v199
    v_mul_f32 v196, v196, v34
    v_mul_f32 v197, v197, v34
    v_mul_f32 v198, v198, v34
    v_mul_f32 v199, v199, v34
    v_cvt_pk_bf16_f32 v196, v196, v197
    v_cvt_pk_bf16_f32 v197, v198, v199
    ds_write_b64 v65, v[196:197] offset:4096
    v_fma_f32 v220, -v31, v44, v220
    v_fma_f32 v221, -v31, v45, v221
    v_fma_f32 v222, -v31, v46, v222
    v_fma_f32 v223, -v31, v47, v223
    v_mul_f32 v220, v220, v35
    v_mul_f32 v221, v221, v35
    v_mul_f32 v222, v222, v35
    v_mul_f32 v223, v223, v35
    v_cvt_pk_bf16_f32 v220, v220, v221
    v_cvt_pk_bf16_f32 v221, v222, v223
    ds_write_b64 v65, v[220:221] offset:6144
    v_fma_f32 v152, -v28, v48, v152
    v_fma_f32 v153, -v28, v49, v153
    v_fma_f32 v154, -v28, v50, v154
    v_fma_f32 v155, -v28, v51, v155
    v_mul_f32 v152, v152, v32
    v_mul_f32 v153, v153, v32
    v_mul_f32 v154, v154, v32
    v_mul_f32 v155, v155, v32
    v_cvt_pk_bf16_f32 v152, v152, v153
    v_cvt_pk_bf16_f32 v153, v154, v155
    ds_write_b64 v66, v[152:153] offset:0
    v_fma_f32 v176, -v29, v48, v176
    v_fma_f32 v177, -v29, v49, v177
    v_fma_f32 v178, -v29, v50, v178
    v_fma_f32 v179, -v29, v51, v179
    v_mul_f32 v176, v176, v33
    v_mul_f32 v177, v177, v33
    v_mul_f32 v178, v178, v33
    v_mul_f32 v179, v179, v33
    v_cvt_pk_bf16_f32 v176, v176, v177
    v_cvt_pk_bf16_f32 v177, v178, v179
    ds_write_b64 v66, v[176:177] offset:2048
    v_fma_f32 v200, -v30, v48, v200
    v_fma_f32 v201, -v30, v49, v201
    v_fma_f32 v202, -v30, v50, v202
    v_fma_f32 v203, -v30, v51, v203
    v_mul_f32 v200, v200, v34
    v_mul_f32 v201, v201, v34
    v_mul_f32 v202, v202, v34
    v_mul_f32 v203, v203, v34
    v_cvt_pk_bf16_f32 v200, v200, v201
    v_cvt_pk_bf16_f32 v201, v202, v203
    ds_write_b64 v66, v[200:201] offset:4096
    v_fma_f32 v224, -v31, v48, v224
    v_fma_f32 v225, -v31, v49, v225
    v_fma_f32 v226, -v31, v50, v226
    v_fma_f32 v227, -v31, v51, v227
    v_mul_f32 v224, v224, v35
    v_mul_f32 v225, v225, v35
    v_mul_f32 v226, v226, v35
    v_mul_f32 v227, v227, v35
    v_cvt_pk_bf16_f32 v224, v224, v225
    v_cvt_pk_bf16_f32 v225, v226, v227
    ds_write_b64 v66, v[224:225] offset:6144
    v_fma_f32 v156, -v28, v52, v156
    v_fma_f32 v157, -v28, v53, v157
    v_fma_f32 v158, -v28, v54, v158
    v_fma_f32 v159, -v28, v55, v159
    v_mul_f32 v156, v156, v32
    v_mul_f32 v157, v157, v32
    v_mul_f32 v158, v158, v32
    v_mul_f32 v159, v159, v32
    v_cvt_pk_bf16_f32 v156, v156, v157
    v_cvt_pk_bf16_f32 v157, v158, v159
    ds_write_b64 v67, v[156:157] offset:0
    v_fma_f32 v180, -v29, v52, v180
    v_fma_f32 v181, -v29, v53, v181
    v_fma_f32 v182, -v29, v54, v182
    v_fma_f32 v183, -v29, v55, v183
    v_mul_f32 v180, v180, v33
    v_mul_f32 v181, v181, v33
    v_mul_f32 v182, v182, v33
    v_mul_f32 v183, v183, v33
    v_cvt_pk_bf16_f32 v180, v180, v181
    v_cvt_pk_bf16_f32 v181, v182, v183
    ds_write_b64 v67, v[180:181] offset:2048
    v_fma_f32 v204, -v30, v52, v204
    v_fma_f32 v205, -v30, v53, v205
    v_fma_f32 v206, -v30, v54, v206
    v_fma_f32 v207, -v30, v55, v207
    v_mul_f32 v204, v204, v34
    v_mul_f32 v205, v205, v34
    v_mul_f32 v206, v206, v34
    v_mul_f32 v207, v207, v34
    v_cvt_pk_bf16_f32 v204, v204, v205
    v_cvt_pk_bf16_f32 v205, v206, v207
    ds_write_b64 v67, v[204:205] offset:4096
    v_fma_f32 v228, -v31, v52, v228
    v_fma_f32 v229, -v31, v53, v229
    v_fma_f32 v230, -v31, v54, v230
    v_fma_f32 v231, -v31, v55, v231
    v_mul_f32 v228, v228, v35
    v_mul_f32 v229, v229, v35
    v_mul_f32 v230, v230, v35
    v_mul_f32 v231, v231, v35
    v_cvt_pk_bf16_f32 v228, v228, v229
    v_cvt_pk_bf16_f32 v229, v230, v231
    ds_write_b64 v67, v[228:229] offset:6144
    v_fma_f32 v160, -v28, v56, v160
    v_fma_f32 v161, -v28, v57, v161
    v_fma_f32 v162, -v28, v58, v162
    v_fma_f32 v163, -v28, v59, v163
    v_mul_f32 v160, v160, v32
    v_mul_f32 v161, v161, v32
    v_mul_f32 v162, v162, v32
    v_mul_f32 v163, v163, v32
    v_cvt_pk_bf16_f32 v160, v160, v161
    v_cvt_pk_bf16_f32 v161, v162, v163
    ds_write_b64 v68, v[160:161] offset:8192
    v_fma_f32 v184, -v29, v56, v184
    v_fma_f32 v185, -v29, v57, v185
    v_fma_f32 v186, -v29, v58, v186
    v_fma_f32 v187, -v29, v59, v187
    v_mul_f32 v184, v184, v33
    v_mul_f32 v185, v185, v33
    v_mul_f32 v186, v186, v33
    v_mul_f32 v187, v187, v33
    v_cvt_pk_bf16_f32 v184, v184, v185
    v_cvt_pk_bf16_f32 v185, v186, v187
    ds_write_b64 v68, v[184:185] offset:9216
    v_fma_f32 v208, -v30, v56, v208
    v_fma_f32 v209, -v30, v57, v209
    v_fma_f32 v210, -v30, v58, v210
    v_fma_f32 v211, -v30, v59, v211
    v_mul_f32 v208, v208, v34
    v_mul_f32 v209, v209, v34
    v_mul_f32 v210, v210, v34
    v_mul_f32 v211, v211, v34
    v_cvt_pk_bf16_f32 v208, v208, v209
    v_cvt_pk_bf16_f32 v209, v210, v211
    ds_write_b64 v68, v[208:209] offset:10240
    v_fma_f32 v232, -v31, v56, v232
    v_fma_f32 v233, -v31, v57, v233
    v_fma_f32 v234, -v31, v58, v234
    v_fma_f32 v235, -v31, v59, v235
    v_mul_f32 v232, v232, v35
    v_mul_f32 v233, v233, v35
    v_mul_f32 v234, v234, v35
    v_mul_f32 v235, v235, v35
    v_cvt_pk_bf16_f32 v232, v232, v233
    v_cvt_pk_bf16_f32 v233, v234, v235
    ds_write_b64 v68, v[232:233] offset:11264
    v_fma_f32 v164, -v28, v60, v164
    v_fma_f32 v165, -v28, v61, v165
    v_fma_f32 v166, -v28, v62, v166
    v_fma_f32 v167, -v28, v63, v167
    v_mul_f32 v164, v164, v32
    v_mul_f32 v165, v165, v32
    v_mul_f32 v166, v166, v32
    v_mul_f32 v167, v167, v32
    v_cvt_pk_bf16_f32 v164, v164, v165
    v_cvt_pk_bf16_f32 v165, v166, v167
    ds_write_b64 v69, v[164:165] offset:8192
    v_fma_f32 v188, -v29, v60, v188
    v_fma_f32 v189, -v29, v61, v189
    v_fma_f32 v190, -v29, v62, v190
    v_fma_f32 v191, -v29, v63, v191
    v_mul_f32 v188, v188, v33
    v_mul_f32 v189, v189, v33
    v_mul_f32 v190, v190, v33
    v_mul_f32 v191, v191, v33
    v_cvt_pk_bf16_f32 v188, v188, v189
    v_cvt_pk_bf16_f32 v189, v190, v191
    ds_write_b64 v69, v[188:189] offset:9216
    v_fma_f32 v212, -v30, v60, v212
    v_fma_f32 v213, -v30, v61, v213
    v_fma_f32 v214, -v30, v62, v214
    v_fma_f32 v215, -v30, v63, v215
    v_mul_f32 v212, v212, v34
    v_mul_f32 v213, v213, v34
    v_mul_f32 v214, v214, v34
    v_mul_f32 v215, v215, v34
    v_cvt_pk_bf16_f32 v212, v212, v213
    v_cvt_pk_bf16_f32 v213, v214, v215
    ds_write_b64 v69, v[212:213] offset:10240
    v_fma_f32 v236, -v31, v60, v236
    v_fma_f32 v237, -v31, v61, v237
    v_fma_f32 v238, -v31, v62, v238
    v_fma_f32 v239, -v31, v63, v239
    v_mul_f32 v236, v236, v35
    v_mul_f32 v237, v237, v35
    v_mul_f32 v238, v238, v35
    v_mul_f32 v239, v239, v35
    v_cvt_pk_bf16_f32 v236, v236, v237
    v_cvt_pk_bf16_f32 v237, v238, v239
    ds_write_b64 v69, v[236:237] offset:11264
    s_waitcnt lgkmcnt(0)
    v_lshrrev_b32 v72, 3, v0
    v_and_b32 v73, 7, v0
    v_and_b32 v74, 7, v72
    v_xor_b32 v74, v74, v73
    v_lshlrev_b32 v74, 4, v74
    v_mul_u32_u24 v75, 128, v72
    v_add3_u32 v74, v74, v75, s27
    s_mul_i32 s25, s20, 128
    s_mul_i32 s26, s23, 64
    s_add_u32 s25, s25, s26
    v_add_u32 v72, s25, v72
    s_mov_b32 s26, 6144
    v_mul_lo_u32 v72, v72, s26
    v_lshlrev_b32 v73, 4, v73
    s_mul_i32 s25, s21, 384
    s_mul_i32 s26, s24, 128
    s_add_u32 s25, s25, s26
    s_add_u32 s25, s25, 0
    v_add3_u32 v72, v72, v73, s25
    ds_read_b128 v[80:83], v74 offset:0
    ds_read_b128 v[84:87], v74 offset:1024
    ds_read_b128 v[88:91], v74 offset:2048
    ds_read_b128 v[92:95], v74 offset:3072
    ds_read_b128 v[96:99], v74 offset:4096
    ds_read_b128 v[100:103], v74 offset:5120
    ds_read_b128 v[104:107], v74 offset:6144
    ds_read_b128 v[108:111], v74 offset:7168
    s_waitcnt lgkmcnt(7)
    buffer_store_dwordx4 v[80:83], v72, s[40:43], 0 offen sc1
    s_waitcnt lgkmcnt(6)
    v_add_u32 v72, 49152, v72
    buffer_store_dwordx4 v[84:87], v72, s[40:43], 0 offen sc1
    s_waitcnt lgkmcnt(5)
    v_add_u32 v72, 49152, v72
    buffer_store_dwordx4 v[88:91], v72, s[40:43], 0 offen sc1
    s_waitcnt lgkmcnt(4)
    v_add_u32 v72, 49152, v72
    buffer_store_dwordx4 v[92:95], v72, s[40:43], 0 offen sc1
    s_waitcnt lgkmcnt(3)
    v_add_u32 v72, 49152, v72
    buffer_store_dwordx4 v[96:99], v72, s[40:43], 0 offen sc1
    s_waitcnt lgkmcnt(2)
    v_add_u32 v72, 49152, v72
    buffer_store_dwordx4 v[100:103], v72, s[40:43], 0 offen sc1
    s_waitcnt lgkmcnt(1)
    v_add_u32 v72, 49152, v72
    buffer_store_dwordx4 v[104:107], v72, s[40:43], 0 offen sc1
    s_waitcnt lgkmcnt(0)
    v_add_u32 v72, 49152, v72
    buffer_store_dwordx4 v[108:111], v72, s[40:43], 0 offen sc1
    s_nop 1
    v_lshrrev_b32 v72, 2, v0
    v_and_b32 v73, 3, v0
    v_and_b32 v74, 3, v72
    v_xor_b32 v74, v74, v73
    v_lshlrev_b32 v74, 4, v74
    v_mul_u32_u24 v75, 64, v72
    v_add3_u32 v74, v74, v75, s27
    s_mul_i32 s25, s20, 128
    s_mul_i32 s26, s23, 64
    s_add_u32 s25, s25, s26
    v_add_u32 v72, s25, v72
    s_mov_b32 s26, 6144
    v_mul_lo_u32 v72, v72, s26
    v_lshlrev_b32 v73, 4, v73
    s_mul_i32 s25, s21, 384
    s_mul_i32 s26, s24, 64
    s_add_u32 s25, s25, s26
    s_add_u32 s25, s25, 256
    v_add3_u32 v72, v72, v73, s25
    ds_read_b128 v[80:83], v74 offset:8192
    ds_read_b128 v[84:87], v74 offset:9216
    ds_read_b128 v[88:91], v74 offset:10240
    ds_read_b128 v[92:95], v74 offset:11264
    s_waitcnt lgkmcnt(3)
    buffer_store_dwordx4 v[80:83], v72, s[40:43], 0 offen sc1
    s_waitcnt lgkmcnt(2)
    v_add_u32 v72, 98304, v72
    buffer_store_dwordx4 v[84:87], v72, s[40:43], 0 offen sc1
    s_waitcnt lgkmcnt(1)
    v_add_u32 v72, 98304, v72
    buffer_store_dwordx4 v[88:91], v72, s[40:43], 0 offen sc1
    s_waitcnt lgkmcnt(0)
    v_add_u32 v72, 98304, v72
    buffer_store_dwordx4 v[92:95], v72, s[40:43], 0 offen sc1
    s_nop 1
g1_kernel_end:
    s_endpgm
.globl attn_kernel
.p2align 8
.type attn_kernel,@function
attn_kernel:
    s_cmp_ge_u32 s2, 656
    s_cbranch_scc1 attn_kernel_end
    s_load_dwordx16 s[64:79], s[0:1], 0
    s_load_dwordx4 s[80:83], s[0:1], 64
    s_waitcnt lgkmcnt(0)
    s_cmp_lt_u32 s2, 144
    s_cbranch_scc1 attn_kernel_cs
    s_sub_u32 s2, s2, 144
    s_add_u32 s4, s82, 4194304
    s_addc_u32 s5, s83, 0
    s_and_b32 s5, s5, 0xffff
    s_mov_b32 s6, 12582912
    s_mov_b32 s7, 0x00020000
    s_add_u32 s8, s82, 16777216
    s_addc_u32 s9, s83, 0
    s_and_b32 s9, s9, 0xffff
    s_mov_b32 s10, 4194304
    s_mov_b32 s11, 0x00020000
    s_and_b32 s20, s2, 31
    s_lshr_b32 s21, s2, 5
    v_lshrrev_b32 v1, 6, v0
    s_nop 0
    v_readfirstlane_b32 s22, v1
    v_and_b32 v0, 63, v0
    v_lshrrev_b32 v1, 2, v0
    v_and_b32 v2, 3, v0
    v_bfe_u32 v3, v0, 4, 2
    v_xor_b32 v2, v2, v3
    v_lshlrev_b32 v2, 4, v2
    s_lshl_b32 s23, s21, 7
    s_mul_i32 s24, s22, 96
    s_add_u32 s23, s23, s24
    s_sub_u32 s23, s23, 256
    v_add_u32 v1, s23, v1
    s_mov_b32 s24, 6144
    v_mul_lo_u32 v1, v1, s24
    v_add_u32 v1, v1, v2
    s_lshl_b32 s24, s20, 6
    v_add_u32 v1, s24, v1
    s_mul_i32 s25, s22, 6144
    v_add_u32 v2, 2048, v1
    s_add_u32 m0, s25, 0
    s_nop 0
    buffer_load_dwordx4 v2, s[4:7], 0 offen lds
    v_add_u32 v2, 100352, v1
    s_add_u32 m0, s25, 1024
    s_nop 0
    buffer_load_dwordx4 v2, s[4:7], 0 offen lds
    v_add_u32 v2, 198656, v1
    s_add_u32 m0, s25, 2048
    s_nop 0
    buffer_load_dwordx4 v2, s[4:7], 0 offen lds
    v_add_u32 v2, 296960, v1
    s_add_u32 m0, s25, 3072
    s_nop 0
    buffer_load_dwordx4 v2, s[4:7], 0 offen lds
    v_add_u32 v2, 395264, v1
    s_add_u32 m0, s25, 4096
    s_nop 0
    buffer_load_dwordx4 v2, s[4:7], 0 offen lds
    v_add_u32 v2, 493568, v1
    s_add_u32 m0, s25, 5120
    s_nop 0
    buffer_load_dwordx4 v2, s[4:7], 0 offen lds
    v_add_u32 v2, 4096, v1
    s_add_u32 m0, s25, 24576
    s_nop 0
    buffer_load_dwordx4 v2, s[4:7], 0 offen lds
    v_add_u32 v2, 102400, v1
    s_add_u32 m0, s25, 25600
    s_nop 0
    buffer_load_dwordx4 v2, s[4:7], 0 offen lds
    v_add_u32 v2, 200704, v1
    s_add_u32 m0, s25, 26624
    s_nop 0
    buffer_load_dwordx4 v2, s[4:7], 0 offen lds
    v_add_u32 v2, 299008, v1
    s_add_u32 m0, s25, 27648
    s_nop 0
    buffer_load_dwordx4 v2, s[4:7], 0 offen lds
    v_add_u32 v2, 397312, v1
    s_add_u32 m0, s25, 28672
    s_nop 0
    buffer_load_dwordx4 v2, s[4:7], 0 offen lds
    v_add_u32 v2, 495616, v1
    s_add_u32 m0, s25, 29696
    s_nop 0
    buffer_load_dwordx4 v2, s[4:7], 0 offen lds
    s_lshl_b32 s23, s21, 7
    s_lshl_b32 s24, s22, 5
    s_add_u32 s23, s23, s24
    v_and_b32 v1, 31, v0
    v_add_u32 v1, s23, v1
    s_mov_b32 s24, 6144
    v_mul_lo_u32 v1, v1, s24
    v_lshrrev_b32 v2, 5, v0
    v_lshlrev_b32 v2, 4, v2
    s_lshl_b32 s24, s20, 6
    v_add3_u32 v1, v1, v2, s24
    buffer_load_dwordx4 v[4:7], v1, s[4:7], 0 offen
    buffer_load_dwordx4 v[8:11], v1, s[4:7], 0 offen offset:32
    v_and_b32 v1, 31, v0
    v_lshlrev_b32 v12, 6, v1
    v_bfe_u32 v2, v0, 2, 2
    v_lshrrev_b32 v3, 5, v0
    v_xor_b32 v13, v3, v2
    v_lshlrev_b32 v13, 4, v13
    v_add_u32 v13, v12, v13
    v_or_b32 v3, 2, v3
    v_xor_b32 v14, v3, v2
    v_lshlrev_b32 v14, 4, v14
    v_add_u32 v14, v12, v14
    s_lshl_b32 s24, s22, 11
    v_add_u32 v13, s24, v13
    v_add_u32 v14, s24, v14
    v_bfe_u32 v1, v0, 5, 1
    v_lshlrev_b32 v1, 2, v1
    v_bfe_u32 v2, v0, 2, 2
    v_add_u32 v1, v1, v2
    v_bfe_u32 v2, v0, 4, 1
    v_lshlrev_b32 v2, 1, v2
    v_bfe_u32 v3, v0, 1, 1
    v_or_b32 v2, v2, v3
    v_and_b32 v3, 1, v0
    v_lshlrev_b32 v3, 3, v3
    v_add_u32 v19, 0, v1
    v_bfe_u32 v20, v19, 2, 2
    v_xor_b32 v20, v20, v2
    v_lshlrev_b32 v20, 4, v20
    v_lshlrev_b32 v19, 6, v19
    v_add3_u32 v15, v19, v20, v3
    v_add_u32 v15, s24, v15
    v_add_u32 v19, 8, v1
    v_bfe_u32 v20, v19, 2, 2
    v_xor_b32 v20, v20, v2
    v_lshlrev_b32 v20, 4, v20
    v_lshlrev_b32 v19, 6, v19
    v_add3_u32 v16, v19, v20, v3
    v_add_u32 v16, s24, v16
    v_add_u32 v19, 16, v1
    v_bfe_u32 v20, v19, 2, 2
    v_xor_b32 v20, v20, v2
    v_lshlrev_b32 v20, 4, v20
    v_lshlrev_b32 v19, 6, v19
    v_add3_u32 v17, v19, v20, v3
    v_add_u32 v17, s24, v17
    v_add_u32 v19, 24, v1
    v_bfe_u32 v20, v19, 2, 2
    v_xor_b32 v20, v20, v2
    v_lshlrev_b32 v20, 4, v20
    v_lshlrev_b32 v19, 6, v19
    v_add3_u32 v18, v19, v20, v3
    v_add_u32 v18, s24, v18
    s_waitcnt vmcnt(0)
    s_barrier
    ds_read_b128 v[20:23], v13 offset:0
    ds_read_b128 v[24:27], v14 offset:0
    ds_read_b128 v[28:31], v13 offset:2048
    ds_read_b128 v[32:35], v14 offset:2048
    s_waitcnt lgkmcnt(2)
    v_mfma_f32_32x32x16_bf16 v[48:63], v[20:23], v[4:7], 0
    v_mfma_f32_32x32x16_bf16 v[48:63], v[24:27], v[8:11], v[48:63]
    ds_read_b128 v[20:23], v13 offset:4096
    ds_read_b128 v[24:27], v14 offset:4096
    s_waitcnt lgkmcnt(2)
    v_mfma_f32_32x32x16_bf16 v[64:79], v[28:31], v[4:7], 0
    v_mfma_f32_32x32x16_bf16 v[64:79], v[32:35], v[8:11], v[64:79]
    ds_read_b128 v[28:31], v13 offset:6144
    ds_read_b128 v[32:35], v14 offset:6144
    s_waitcnt lgkmcnt(2)
    v_mfma_f32_32x32x16_bf16 v[80:95], v[20:23], v[4:7], 0
    v_mfma_f32_32x32x16_bf16 v[80:95], v[24:27], v[8:11], v[80:95]
    ds_read_b128 v[20:23], v13 offset:8192
    ds_read_b128 v[24:27], v14 offset:8192
    s_waitcnt lgkmcnt(2)
    v_mfma_f32_32x32x16_bf16 v[96:111], v[28:31], v[4:7], 0
    v_mfma_f32_32x32x16_bf16 v[96:111], v[32:35], v[8:11], v[96:111]
    ds_read_b128 v[28:31], v13 offset:10240
    ds_read_b128 v[32:35], v14 offset:10240
    s_waitcnt lgkmcnt(2)
    v_mfma_f32_32x32x16_bf16 v[112:127], v[20:23], v[4:7], 0
    v_mfma_f32_32x32x16_bf16 v[112:127], v[24:27], v[8:11], v[112:127]
    ds_read_b128 v[20:23], v13 offset:12288
    ds_read_b128 v[24:27], v14 offset:12288
    s_waitcnt lgkmcnt(2)
    v_mfma_f32_32x32x16_bf16 v[128:143], v[28:31], v[4:7], 0
    v_mfma_f32_32x32x16_bf16 v[128:143], v[32:35], v[8:11], v[128:143]
    ds_read_b128 v[28:31], v13 offset:14336
    ds_read_b128 v[32:35], v14 offset:14336
    s_waitcnt lgkmcnt(2)
    v_mfma_f32_32x32x16_bf16 v[144:159], v[20:23], v[4:7], 0
    v_mfma_f32_32x32x16_bf16 v[144:159], v[24:27], v[8:11], v[144:159]
    ds_read_b128 v[20:23], v13 offset:16384
    ds_read_b128 v[24:27], v14 offset:16384
    s_waitcnt lgkmcnt(2)
    v_mfma_f32_32x32x16_bf16 v[160:175], v[28:31], v[4:7], 0
    v_mfma_f32_32x32x16_bf16 v[160:175], v[32:35], v[8:11], v[160:175]
    s_waitcnt lgkmcnt(0)
    v_mfma_f32_32x32x16_bf16 v[176:191], v[20:23], v[4:7], 0
    v_mfma_f32_32x32x16_bf16 v[176:191], v[24:27], v[8:11], v[176:191]
    s_nop 15
    s_mov_b32 s26, 0x3e8293ee
    v_and_b32 v1, 31, v0
    v_lshrrev_b32 v2, 5, v0
    v_lshlrev_b32 v2, 2, v2
    v_sub_u32 v1, v1, v2
    v_mov_b32 v3, 0xce6e6b28
    v_cmp_ge_i32 vcc, v1, 0
    s_nop 1
    v_cndmask_b32 v48, v48, v3, vcc
    v_cndmask_b32 v176, v3, v176, vcc
    v_cmp_ge_i32 vcc, v1, 1
    s_nop 1
    v_cndmask_b32 v49, v49, v3, vcc
    v_cndmask_b32 v177, v3, v177, vcc
    v_cmp_ge_i32 vcc, v1, 2
    s_nop 1
    v_cndmask_b32 v50, v50, v3, vcc
    v_cndmask_b32 v178, v3, v178, vcc
    v_cmp_ge_i32 vcc, v1, 3
    s_nop 1
    v_cndmask_b32 v51, v51, v3, vcc
    v_cndmask_b32 v179, v3, v179, vcc
    v_cmp_ge_i32 vcc, v1, 8
    s_nop 1
    v_cndmask_b32 v52, v52, v3, vcc
    v_cndmask_b32 v180, v3, v180, vcc
    v_cmp_ge_i32 vcc, v1, 9
    s_nop 1
    v_cndmask_b32 v53, v53, v3, vcc
    v_cndmask_b32 v181, v3, v181, vcc
    v_cmp_ge_i32 vcc, v1, 10
    s_nop 1
    v_cndmask_b32 v54, v54, v3, vcc
    v_cndmask_b32 v182, v3, v182, vcc
    v_cmp_ge_i32 vcc, v1, 11
    s_nop 1
    v_cndmask_b32 v55, v55, v3, vcc
    v_cndmask_b32 v183, v3, v183, vcc
    v_cmp_ge_i32 vcc, v1, 16
    s_nop 1
    v_cndmask_b32 v56, v56, v3, vcc
    v_cndmask_b32 v184, v3, v184, vcc
    v_cmp_ge_i32 vcc, v1, 17
    s_nop 1
    v_cndmask_b32 v57, v57, v3, vcc
    v_cndmask_b32 v185, v3, v185, vcc
    v_cmp_ge_i32 vcc, v1, 18
    s_nop 1
    v_cndmask_b32 v58, v58, v3, vcc
    v_cndmask_b32 v186, v3, v186, vcc
    v_cmp_ge_i32 vcc, v1, 19
    s_nop 1
    v_cndmask_b32 v59, v59, v3, vcc
    v_cndmask_b32 v187, v3, v187, vcc
    v_cmp_ge_i32 vcc, v1, 24
    s_nop 1
    v_cndmask_b32 v60, v60, v3, vcc
    v_cndmask_b32 v188, v3, v188, vcc
    v_cmp_ge_i32 vcc, v1, 25
    s_nop 1
    v_cndmask_b32 v61, v61, v3, vcc
    v_cndmask_b32 v189, v3, v189, vcc
    v_cmp_ge_i32 vcc, v1, 26
    s_nop 1
    v_cndmask_b32 v62, v62, v3, vcc
    v_cndmask_b32 v190, v3, v190, vcc
    v_cmp_ge_i32 vcc, v1, 27
    s_nop 1
    v_cndmask_b32 v63, v63, v3, vcc
    v_cndmask_b32 v191, v3, v191, vcc
    s_lshl_b32 s23, s21, 2
    s_add_u32 s23, s23, s22
    s_cmp_ge_u32 s23, 8
    s_cbranch_scc1 attn_kernel_nomask
    s_cmp_lt_u32 s23, 8
    s_cbranch_scc0 attn_kernel_nm0
    v_mov_b32 v48, v3
    v_mov_b32 v49, v3
    v_mov_b32 v50, v3
    v_mov_b32 v51, v3
    v_mov_b32 v52, v3
    v_mov_b32 v53, v3
    v_mov_b32 v54, v3
    v_mov_b32 v55, v3
    v_mov_b32 v56, v3
    v_mov_b32 v57, v3
    v_mov_b32 v58, v3
    v_mov_b32 v59, v3
    v_mov_b32 v60, v3
    v_mov_b32 v61, v3
    v_mov_b32 v62, v3
    v_mov_b32 v63, v3
attn_kernel_nm0:
    s_cmp_lt_u32 s23, 7
    s_cbranch_scc0 attn_kernel_nm1
    v_mov_b32 v64, v3
    v_mov_b32 v65, v3
    v_mov_b32 v66, v3
    v_mov_b32 v67, v3
    v_mov_b32 v68, v3
    v_mov_b32 v69, v3
    v_mov_b32 v70, v3
    v_mov_b32 v71, v3
    v_mov_b32 v72, v3
    v_mov_b32 v73, v3
    v_mov_b32 v74, v3
    v_mov_b32 v75, v3
    v_mov_b32 v76, v3
    v_mov_b32 v77, v3
    v_mov_b32 v78, v3
    v_mov_b32 v79, v3
attn_kernel_nm1:
    s_cmp_lt_u32 s23, 6
    s_cbranch_scc0 attn_kernel_nm2
    v_mov_b32 v80, v3
    v_mov_b32 v81, v3
    v_mov_b32 v82, v3
    v_mov_b32 v83, v3
    v_mov_b32 v84, v3
    v_mov_b32 v85, v3
    v_mov_b32 v86, v3
    v_mov_b32 v87, v3
    v_mov_b32 v88, v3
    v_mov_b32 v89, v3
    v_mov_b32 v90, v3
    v_mov_b32 v91, v3
    v_mov_b32 v92, v3
    v_mov_b32 v93, v3
    v_mov_b32 v94, v3
    v_mov_b32 v95, v3
attn_kernel_nm2:
    s_cmp_lt_u32 s23, 5
    s_cbranch_scc0 attn_kernel_nm3
    v_mov_b32 v96, v3
    v_mov_b32 v97, v3
    v_mov_b32 v98, v3
    v_mov_b32 v99, v3
    v_mov_b32 v100, v3
    v_mov_b32 v101, v3
    v_mov_b32 v102, v3
    v_mov_b32 v103, v3
    v_mov_b32 v104, v3
    v_mov_b32 v105, v3
    v_mov_b32 v106, v3
    v_mov_b32 v107, v3
    v_mov_b32 v108, v3
    v_mov_b32 v109, v3
    v_mov_b32 v110, v3
    v_mov_b32 v111, v3
attn_kernel_nm3:
    s_cmp_lt_u32 s23, 4
    s_cbranch_scc0 attn_kernel_nm4
    v_mov_b32 v112, v3
    v_mov_b32 v113, v3
    v_mov_b32 v114, v3
    v_mov_b32 v115, v3
    v_mov_b32 v116, v3
    v_mov_b32 v117, v3
    v_mov_b32 v118, v3
    v_mov_b32 v119, v3
    v_mov_b32 v120, v3
    v_mov_b32 v121, v3
    v_mov_b32 v122, v3
    v_mov_b32 v123, v3
    v_mov_b32 v124, v3
    v_mov_b32 v125, v3
    v_mov_b32 v126, v3
    v_mov_b32 v127, v3
attn_kernel_nm4:
    s_cmp_lt_u32 s23, 3
    s_cbranch_scc0 attn_kernel_nm5
    v_mov_b32 v128, v3
    v_mov_b32 v129, v3
    v_mov_b32 v130, v3
    v_mov_b32 v131, v3
    v_mov_b32 v132, v3
    v_mov_b32 v133, v3
    v_mov_b32 v134, v3
    v_mov_b32 v135, v3
    v_mov_b32 v136, v3
    v_mov_b32 v137, v3
    v_mov_b32 v138, v3
    v_mov_b32 v139, v3
    v_mov_b32 v140, v3
    v_mov_b32 v141, v3
    v_mov_b32 v142, v3
    v_mov_b32 v143, v3
attn_kernel_nm5:
    s_cmp_lt_u32 s23, 2
    s_cbranch_scc0 attn_kernel_nm6
    v_mov_b32 v144, v3
    v_mov_b32 v145, v3
    v_mov_b32 v146, v3
    v_mov_b32 v147, v3
    v_mov_b32 v148, v3
    v_mov_b32 v149, v3
    v_mov_b32 v150, v3
    v_mov_b32 v151, v3
    v_mov_b32 v152, v3
    v_mov_b32 v153, v3
    v_mov_b32 v154, v3
    v_mov_b32 v155, v3
    v_mov_b32 v156, v3
    v_mov_b32 v157, v3
    v_mov_b32 v158, v3
    v_mov_b32 v159, v3
attn_kernel_nm6:
    s_cmp_lt_u32 s23, 1
    s_cbranch_scc0 attn_kernel_nm7
    v_mov_b32 v160, v3
    v_mov_b32 v161, v3
    v_mov_b32 v162, v3
    v_mov_b32 v163, v3
    v_mov_b32 v164, v3
    v_mov_b32 v165, v3
    v_mov_b32 v166, v3
    v_mov_b32 v167, v3
    v_mov_b32 v168, v3
    v_mov_b32 v169, v3
    v_mov_b32 v170, v3
    v_mov_b32 v171, v3
    v_mov_b32 v172, v3
    v_mov_b32 v173, v3
    v_mov_b32 v174, v3
    v_mov_b32 v175, v3
attn_kernel_nm7:
attn_kernel_nomask:
    v_max_f32 v1, v48, v49
    v_max3_f32 v1, v1, v50, v51
    v_max3_f32 v1, v1, v52, v53
    v_max3_f32 v1, v1, v54, v55
    v_max3_f32 v1, v1, v56, v57
    v_max3_f32 v1, v1, v58, v59
    v_max3_f32 v1, v1, v60, v61
    v_max3_f32 v1, v1, v62, v63
    v_max3_f32 v1, v1, v64, v65
    v_max3_f32 v1, v1, v66, v67
    v_max3_f32 v1, v1, v68, v69
    v_max3_f32 v1, v1, v70, v71
    v_max3_f32 v1, v1, v72, v73
    v_max3_f32 v1, v1, v74, v75
    v_max3_f32 v1, v1, v76, v77
    v_max3_f32 v1, v1, v78, v79
    v_max3_f32 v1, v1, v80, v81
    v_max3_f32 v1, v1, v82, v83
    v_max3_f32 v1, v1, v84, v85
    v_max3_f32 v1, v1, v86, v87
    v_max3_f32 v1, v1, v88, v89
    v_max3_f32 v1, v1, v90, v91
    v_max3_f32 v1, v1, v92, v93
    v_max3_f32 v1, v1, v94, v95
    v_max3_f32 v1, v1, v96, v97
    v_max3_f32 v1, v1, v98, v99
    v_max3_f32 v1, v1, v100, v101
    v_max3_f32 v1, v1, v102, v103
    v_max3_f32 v1, v1, v104, v105
    v_max3_f32 v1, v1, v106, v107
    v_max3_f32 v1, v1, v108, v109
    v_max3_f32 v1, v1, v110, v111
    v_max3_f32 v1, v1, v112, v113
    v_max3_f32 v1, v1, v114, v115
    v_max3_f32 v1, v1, v116, v117
    v_max3_f32 v1, v1, v118, v119
    v_max3_f32 v1, v1, v120, v121
    v_max3_f32 v1, v1, v122, v123
    v_max3_f32 v1, v1, v124, v125
    v_max3_f32 v1, v1, v126, v127
    v_max3_f32 v1, v1, v128, v129
    v_max3_f32 v1, v1, v130, v131
    v_max3_f32 v1, v1, v132, v133
    v_max3_f32 v1, v1, v134, v135
    v_max3_f32 v1, v1, v136, v137
    v_max3_f32 v1, v1, v138, v139
    v_max3_f32 v1, v1, v140, v141
    v_max3_f32 v1, v1, v142, v143
    v_max3_f32 v1, v1, v144, v145
    v_max3_f32 v1, v1, v146, v147
    v_max3_f32 v1, v1, v148, v149
    v_max3_f32 v1, v1, v150, v151
    v_max3_f32 v1, v1, v152, v153
    v_max3_f32 v1, v1, v154, v155
    v_max3_f32 v1, v1, v156, v157
    v_max3_f32 v1, v1, v158, v159
    v_max3_f32 v1, v1, v160, v161
    v_max3_f32 v1, v1, v162, v163
    v_max3_f32 v1, v1, v164, v165
    v_max3_f32 v1, v1, v166, v167
    v_max3_f32 v1, v1, v168, v169
    v_max3_f32 v1, v1, v170, v171
    v_max3_f32 v1, v1, v172, v173
    v_max3_f32 v1, v1, v174, v175
    v_max3_f32 v1, v1, v176, v177
    v_max3_f32 v1, v1, v178, v179
    v_max3_f32 v1, v1, v180, v181
    v_max3_f32 v1, v1, v182, v183
    v_max3_f32 v1, v1, v184, v185
    v_max3_f32 v1, v1, v186, v187
    v_max3_f32 v1, v1, v188, v189
    v_max3_f32 v1, v1, v190, v191
    v_mov_b32 v2, v1
    s_nop 1
    v_permlane32_swap_b32 v1, v2
    v_max_f32 v1, v1, v2
    v_mul_f32 v1, s26, v1
    v_sub_f32 v36, 0, v1
    v_sub_f32 v37, 0, v1
    v_mov_b32 v38, s26
    v_mov_b32 v39, s26
    v_mov_b32 v2, 0
    v_mov_b32 v3, 0
    v_pk_fma_f32 v[48:49], v[48:49], v[38:39], v[36:37]
    v_pk_fma_f32 v[50:51], v[50:51], v[38:39], v[36:37]
    v_pk_fma_f32 v[52:53], v[52:53], v[38:39], v[36:37]
    v_pk_fma_f32 v[54:55], v[54:55], v[38:39], v[36:37]
    v_pk_fma_f32 v[56:57], v[56:57], v[38:39], v[36:37]
    v_pk_fma_f32 v[58:59], v[58:59], v[38:39], v[36:37]
    v_pk_fma_f32 v[60:61], v[60:61], v[38:39], v[36:37]
    v_pk_fma_f32 v[62:63], v[62:63], v[38:39], v[36:37]
    v_exp_f32 v48, v48
    v_exp_f32 v49, v49
    v_exp_f32 v50, v50
    v_exp_f32 v51, v51
    v_exp_f32 v52, v52
    v_exp_f32 v53, v53
    v_exp_f32 v54, v54
    v_exp_f32 v55, v55
    v_exp_f32 v56, v56
    v_exp_f32 v57, v57
    v_exp_f32 v58, v58
    v_exp_f32 v59, v59
    v_exp_f32 v60, v60
    v_exp_f32 v61, v61
    v_exp_f32 v62, v62
    v_exp_f32 v63, v63
    s_nop 0
    v_pk_add_f32 v[2:3], v[2:3], v[48:49]
    v_cvt_pk_bf16_f32 v48, v48, v49
    v_pk_add_f32 v[2:3], v[2:3], v[50:51]
    v_cvt_pk_bf16_f32 v49, v50, v51
    v_pk_add_f32 v[2:3], v[2:3], v[52:53]
    v_cvt_pk_bf16_f32 v50, v52, v53
    v_pk_add_f32 v[2:3], v[2:3], v[54:55]
    v_cvt_pk_bf16_f32 v51, v54, v55
    v_pk_add_f32 v[2:3], v[2:3], v[56:57]
    v_cvt_pk_bf16_f32 v52, v56, v57
    v_pk_add_f32 v[2:3], v[2:3], v[58:59]
    v_cvt_pk_bf16_f32 v53, v58, v59
    v_pk_add_f32 v[2:3], v[2:3], v[60:61]
    v_cvt_pk_bf16_f32 v54, v60, v61
    v_pk_add_f32 v[2:3], v[2:3], v[62:63]
    v_cvt_pk_bf16_f32 v55, v62, v63
    v_pk_fma_f32 v[64:65], v[64:65], v[38:39], v[36:37]
    v_pk_fma_f32 v[66:67], v[66:67], v[38:39], v[36:37]
    v_pk_fma_f32 v[68:69], v[68:69], v[38:39], v[36:37]
    v_pk_fma_f32 v[70:71], v[70:71], v[38:39], v[36:37]
    v_pk_fma_f32 v[72:73], v[72:73], v[38:39], v[36:37]
    v_pk_fma_f32 v[74:75], v[74:75], v[38:39], v[36:37]
    v_pk_fma_f32 v[76:77], v[76:77], v[38:39], v[36:37]
    v_pk_fma_f32 v[78:79], v[78:79], v[38:39], v[36:37]
    v_exp_f32 v64, v64
    v_exp_f32 v65, v65
    v_exp_f32 v66, v66
    v_exp_f32 v67, v67
    v_exp_f32 v68, v68
    v_exp_f32 v69, v69
    v_exp_f32 v70, v70
    v_exp_f32 v71, v71
    v_exp_f32 v72, v72
    v_exp_f32 v73, v73
    v_exp_f32 v74, v74
    v_exp_f32 v75, v75
    v_exp_f32 v76, v76
    v_exp_f32 v77, v77
    v_exp_f32 v78, v78
    v_exp_f32 v79, v79
    s_nop 0
    v_pk_add_f32 v[2:3], v[2:3], v[64:65]
    v_cvt_pk_bf16_f32 v64, v64, v65
    v_pk_add_f32 v[2:3], v[2:3], v[66:67]
    v_cvt_pk_bf16_f32 v65, v66, v67
    v_pk_add_f32 v[2:3], v[2:3], v[68:69]
    v_cvt_pk_bf16_f32 v66, v68, v69
    v_pk_add_f32 v[2:3], v[2:3], v[70:71]
    v_cvt_pk_bf16_f32 v67, v70, v71
    v_pk_add_f32 v[2:3], v[2:3], v[72:73]
    v_cvt_pk_bf16_f32 v68, v72, v73
    v_pk_add_f32 v[2:3], v[2:3], v[74:75]
    v_cvt_pk_bf16_f32 v69, v74, v75
    v_pk_add_f32 v[2:3], v[2:3], v[76:77]
    v_cvt_pk_bf16_f32 v70, v76, v77
    v_pk_add_f32 v[2:3], v[2:3], v[78:79]
    v_cvt_pk_bf16_f32 v71, v78, v79
    v_pk_fma_f32 v[80:81], v[80:81], v[38:39], v[36:37]
    v_pk_fma_f32 v[82:83], v[82:83], v[38:39], v[36:37]
    v_pk_fma_f32 v[84:85], v[84:85], v[38:39], v[36:37]
    v_pk_fma_f32 v[86:87], v[86:87], v[38:39], v[36:37]
    v_pk_fma_f32 v[88:89], v[88:89], v[38:39], v[36:37]
    v_pk_fma_f32 v[90:91], v[90:91], v[38:39], v[36:37]
    v_pk_fma_f32 v[92:93], v[92:93], v[38:39], v[36:37]
    v_pk_fma_f32 v[94:95], v[94:95], v[38:39], v[36:37]
    v_exp_f32 v80, v80
    v_exp_f32 v81, v81
    v_exp_f32 v82, v82
    v_exp_f32 v83, v83
    v_exp_f32 v84, v84
    v_exp_f32 v85, v85
    v_exp_f32 v86, v86
    v_exp_f32 v87, v87
    v_exp_f32 v88, v88
    v_exp_f32 v89, v89
    v_exp_f32 v90, v90
    v_exp_f32 v91, v91
    v_exp_f32 v92, v92
    v_exp_f32 v93, v93
    v_exp_f32 v94, v94
    v_exp_f32 v95, v95
    s_nop 0
    v_pk_add_f32 v[2:3], v[2:3], v[80:81]
    v_cvt_pk_bf16_f32 v80, v80, v81
    v_pk_add_f32 v[2:3], v[2:3], v[82:83]
    v_cvt_pk_bf16_f32 v81, v82, v83
    v_pk_add_f32 v[2:3], v[2:3], v[84:85]
    v_cvt_pk_bf16_f32 v82, v84, v85
    v_pk_add_f32 v[2:3], v[2:3], v[86:87]
    v_cvt_pk_bf16_f32 v83, v86, v87
    v_pk_add_f32 v[2:3], v[2:3], v[88:89]
    v_cvt_pk_bf16_f32 v84, v88, v89
    v_pk_add_f32 v[2:3], v[2:3], v[90:91]
    v_cvt_pk_bf16_f32 v85, v90, v91
    v_pk_add_f32 v[2:3], v[2:3], v[92:93]
    v_cvt_pk_bf16_f32 v86, v92, v93
    v_pk_add_f32 v[2:3], v[2:3], v[94:95]
    v_cvt_pk_bf16_f32 v87, v94, v95
    v_pk_fma_f32 v[96:97], v[96:97], v[38:39], v[36:37]
    v_pk_fma_f32 v[98:99], v[98:99], v[38:39], v[36:37]
    v_pk_fma_f32 v[100:101], v[100:101], v[38:39], v[36:37]
    v_pk_fma_f32 v[102:103], v[102:103], v[38:39], v[36:37]
    v_pk_fma_f32 v[104:105], v[104:105], v[38:39], v[36:37]
    v_pk_fma_f32 v[106:107], v[106:107], v[38:39], v[36:37]
    v_pk_fma_f32 v[108:109], v[108:109], v[38:39], v[36:37]
    v_pk_fma_f32 v[110:111], v[110:111], v[38:39], v[36:37]
    v_exp_f32 v96, v96
    v_exp_f32 v97, v97
    v_exp_f32 v98, v98
    v_exp_f32 v99, v99
    v_exp_f32 v100, v100
    v_exp_f32 v101, v101
    v_exp_f32 v102, v102
    v_exp_f32 v103, v103
    v_exp_f32 v104, v104
    v_exp_f32 v105, v105
    v_exp_f32 v106, v106
    v_exp_f32 v107, v107
    v_exp_f32 v108, v108
    v_exp_f32 v109, v109
    v_exp_f32 v110, v110
    v_exp_f32 v111, v111
    s_nop 0
    v_pk_add_f32 v[2:3], v[2:3], v[96:97]
    v_cvt_pk_bf16_f32 v96, v96, v97
    v_pk_add_f32 v[2:3], v[2:3], v[98:99]
    v_cvt_pk_bf16_f32 v97, v98, v99
    v_pk_add_f32 v[2:3], v[2:3], v[100:101]
    v_cvt_pk_bf16_f32 v98, v100, v101
    v_pk_add_f32 v[2:3], v[2:3], v[102:103]
    v_cvt_pk_bf16_f32 v99, v102, v103
    v_pk_add_f32 v[2:3], v[2:3], v[104:105]
    v_cvt_pk_bf16_f32 v100, v104, v105
    v_pk_add_f32 v[2:3], v[2:3], v[106:107]
    v_cvt_pk_bf16_f32 v101, v106, v107
    v_pk_add_f32 v[2:3], v[2:3], v[108:109]
    v_cvt_pk_bf16_f32 v102, v108, v109
    v_pk_add_f32 v[2:3], v[2:3], v[110:111]
    v_cvt_pk_bf16_f32 v103, v110, v111
    v_pk_fma_f32 v[112:113], v[112:113], v[38:39], v[36:37]
    v_pk_fma_f32 v[114:115], v[114:115], v[38:39], v[36:37]
    v_pk_fma_f32 v[116:117], v[116:117], v[38:39], v[36:37]
    v_pk_fma_f32 v[118:119], v[118:119], v[38:39], v[36:37]
    v_pk_fma_f32 v[120:121], v[120:121], v[38:39], v[36:37]
    v_pk_fma_f32 v[122:123], v[122:123], v[38:39], v[36:37]
    v_pk_fma_f32 v[124:125], v[124:125], v[38:39], v[36:37]
    v_pk_fma_f32 v[126:127], v[126:127], v[38:39], v[36:37]
    v_exp_f32 v112, v112
    v_exp_f32 v113, v113
    v_exp_f32 v114, v114
    v_exp_f32 v115, v115
    v_exp_f32 v116, v116
    v_exp_f32 v117, v117
    v_exp_f32 v118, v118
    v_exp_f32 v119, v119
    v_exp_f32 v120, v120
    v_exp_f32 v121, v121
    v_exp_f32 v122, v122
    v_exp_f32 v123, v123
    v_exp_f32 v124, v124
    v_exp_f32 v125, v125
    v_exp_f32 v126, v126
    v_exp_f32 v127, v127
    s_nop 0
    v_pk_add_f32 v[2:3], v[2:3], v[112:113]
    v_cvt_pk_bf16_f32 v112, v112, v113
    v_pk_add_f32 v[2:3], v[2:3], v[114:115]
    v_cvt_pk_bf16_f32 v113, v114, v115
    v_pk_add_f32 v[2:3], v[2:3], v[116:117]
    v_cvt_pk_bf16_f32 v114, v116, v117
    v_pk_add_f32 v[2:3], v[2:3], v[118:119]
    v_cvt_pk_bf16_f32 v115, v118, v119
    v_pk_add_f32 v[2:3], v[2:3], v[120:121]
    v_cvt_pk_bf16_f32 v116, v120, v121
    v_pk_add_f32 v[2:3], v[2:3], v[122:123]
    v_cvt_pk_bf16_f32 v117, v122, v123
    v_pk_add_f32 v[2:3], v[2:3], v[124:125]
    v_cvt_pk_bf16_f32 v118, v124, v125
    v_pk_add_f32 v[2:3], v[2:3], v[126:127]
    v_cvt_pk_bf16_f32 v119, v126, v127
    v_pk_fma_f32 v[128:129], v[128:129], v[38:39], v[36:37]
    v_pk_fma_f32 v[130:131], v[130:131], v[38:39], v[36:37]
    v_pk_fma_f32 v[132:133], v[132:133], v[38:39], v[36:37]
    v_pk_fma_f32 v[134:135], v[134:135], v[38:39], v[36:37]
    v_pk_fma_f32 v[136:137], v[136:137], v[38:39], v[36:37]
    v_pk_fma_f32 v[138:139], v[138:139], v[38:39], v[36:37]
    v_pk_fma_f32 v[140:141], v[140:141], v[38:39], v[36:37]
    v_pk_fma_f32 v[142:143], v[142:143], v[38:39], v[36:37]
    v_exp_f32 v128, v128
    v_exp_f32 v129, v129
    v_exp_f32 v130, v130
    v_exp_f32 v131, v131
    v_exp_f32 v132, v132
    v_exp_f32 v133, v133
    v_exp_f32 v134, v134
    v_exp_f32 v135, v135
    v_exp_f32 v136, v136
    v_exp_f32 v137, v137
    v_exp_f32 v138, v138
    v_exp_f32 v139, v139
    v_exp_f32 v140, v140
    v_exp_f32 v141, v141
    v_exp_f32 v142, v142
    v_exp_f32 v143, v143
    s_nop 0
    v_pk_add_f32 v[2:3], v[2:3], v[128:129]
    v_cvt_pk_bf16_f32 v128, v128, v129
    v_pk_add_f32 v[2:3], v[2:3], v[130:131]
    v_cvt_pk_bf16_f32 v129, v130, v131
    v_pk_add_f32 v[2:3], v[2:3], v[132:133]
    v_cvt_pk_bf16_f32 v130, v132, v133
    v_pk_add_f32 v[2:3], v[2:3], v[134:135]
    v_cvt_pk_bf16_f32 v131, v134, v135
    v_pk_add_f32 v[2:3], v[2:3], v[136:137]
    v_cvt_pk_bf16_f32 v132, v136, v137
    v_pk_add_f32 v[2:3], v[2:3], v[138:139]
    v_cvt_pk_bf16_f32 v133, v138, v139
    v_pk_add_f32 v[2:3], v[2:3], v[140:141]
    v_cvt_pk_bf16_f32 v134, v140, v141
    v_pk_add_f32 v[2:3], v[2:3], v[142:143]
    v_cvt_pk_bf16_f32 v135, v142, v143
    v_pk_fma_f32 v[144:145], v[144:145], v[38:39], v[36:37]
    v_pk_fma_f32 v[146:147], v[146:147], v[38:39], v[36:37]
    v_pk_fma_f32 v[148:149], v[148:149], v[38:39], v[36:37]
    v_pk_fma_f32 v[150:151], v[150:151], v[38:39], v[36:37]
    v_pk_fma_f32 v[152:153], v[152:153], v[38:39], v[36:37]
    v_pk_fma_f32 v[154:155], v[154:155], v[38:39], v[36:37]
    v_pk_fma_f32 v[156:157], v[156:157], v[38:39], v[36:37]
    v_pk_fma_f32 v[158:159], v[158:159], v[38:39], v[36:37]
    v_exp_f32 v144, v144
    v_exp_f32 v145, v145
    v_exp_f32 v146, v146
    v_exp_f32 v147, v147
    v_exp_f32 v148, v148
    v_exp_f32 v149, v149
    v_exp_f32 v150, v150
    v_exp_f32 v151, v151
    v_exp_f32 v152, v152
    v_exp_f32 v153, v153
    v_exp_f32 v154, v154
    v_exp_f32 v155, v155
    v_exp_f32 v156, v156
    v_exp_f32 v157, v157
    v_exp_f32 v158, v158
    v_exp_f32 v159, v159
    s_nop 0
    v_pk_add_f32 v[2:3], v[2:3], v[144:145]
    v_cvt_pk_bf16_f32 v144, v144, v145
    v_pk_add_f32 v[2:3], v[2:3], v[146:147]
    v_cvt_pk_bf16_f32 v145, v146, v147
    v_pk_add_f32 v[2:3], v[2:3], v[148:149]
    v_cvt_pk_bf16_f32 v146, v148, v149
    v_pk_add_f32 v[2:3], v[2:3], v[150:151]
    v_cvt_pk_bf16_f32 v147, v150, v151
    v_pk_add_f32 v[2:3], v[2:3], v[152:153]
    v_cvt_pk_bf16_f32 v148, v152, v153
    v_pk_add_f32 v[2:3], v[2:3], v[154:155]
    v_cvt_pk_bf16_f32 v149, v154, v155
    v_pk_add_f32 v[2:3], v[2:3], v[156:157]
    v_cvt_pk_bf16_f32 v150, v156, v157
    v_pk_add_f32 v[2:3], v[2:3], v[158:159]
    v_cvt_pk_bf16_f32 v151, v158, v159
    v_pk_fma_f32 v[160:161], v[160:161], v[38:39], v[36:37]
    v_pk_fma_f32 v[162:163], v[162:163], v[38:39], v[36:37]
    v_pk_fma_f32 v[164:165], v[164:165], v[38:39], v[36:37]
    v_pk_fma_f32 v[166:167], v[166:167], v[38:39], v[36:37]
    v_pk_fma_f32 v[168:169], v[168:169], v[38:39], v[36:37]
    v_pk_fma_f32 v[170:171], v[170:171], v[38:39], v[36:37]
    v_pk_fma_f32 v[172:173], v[172:173], v[38:39], v[36:37]
    v_pk_fma_f32 v[174:175], v[174:175], v[38:39], v[36:37]
    v_exp_f32 v160, v160
    v_exp_f32 v161, v161
    v_exp_f32 v162, v162
    v_exp_f32 v163, v163
    v_exp_f32 v164, v164
    v_exp_f32 v165, v165
    v_exp_f32 v166, v166
    v_exp_f32 v167, v167
    v_exp_f32 v168, v168
    v_exp_f32 v169, v169
    v_exp_f32 v170, v170
    v_exp_f32 v171, v171
    v_exp_f32 v172, v172
    v_exp_f32 v173, v173
    v_exp_f32 v174, v174
    v_exp_f32 v175, v175
    s_nop 0
    v_pk_add_f32 v[2:3], v[2:3], v[160:161]
    v_cvt_pk_bf16_f32 v160, v160, v161
    v_pk_add_f32 v[2:3], v[2:3], v[162:163]
    v_cvt_pk_bf16_f32 v161, v162, v163
    v_pk_add_f32 v[2:3], v[2:3], v[164:165]
    v_cvt_pk_bf16_f32 v162, v164, v165
    v_pk_add_f32 v[2:3], v[2:3], v[166:167]
    v_cvt_pk_bf16_f32 v163, v166, v167
    v_pk_add_f32 v[2:3], v[2:3], v[168:169]
    v_cvt_pk_bf16_f32 v164, v168, v169
    v_pk_add_f32 v[2:3], v[2:3], v[170:171]
    v_cvt_pk_bf16_f32 v165, v170, v171
    v_pk_add_f32 v[2:3], v[2:3], v[172:173]
    v_cvt_pk_bf16_f32 v166, v172, v173
    v_pk_add_f32 v[2:3], v[2:3], v[174:175]
    v_cvt_pk_bf16_f32 v167, v174, v175
    v_pk_fma_f32 v[176:177], v[176:177], v[38:39], v[36:37]
    v_pk_fma_f32 v[178:179], v[178:179], v[38:39], v[36:37]
    v_pk_fma_f32 v[180:181], v[180:181], v[38:39], v[36:37]
    v_pk_fma_f32 v[182:183], v[182:183], v[38:39], v[36:37]
    v_pk_fma_f32 v[184:185], v[184:185], v[38:39], v[36:37]
    v_pk_fma_f32 v[186:187], v[186:187], v[38:39], v[36:37]
    v_pk_fma_f32 v[188:189], v[188:189], v[38:39], v[36:37]
    v_pk_fma_f32 v[190:191], v[190:191], v[38:39], v[36:37]
    v_exp_f32 v176, v176
    v_exp_f32 v177, v177
    v_exp_f32 v178, v178
    v_exp_f32 v179, v179
    v_exp_f32 v180, v180
    v_exp_f32 v181, v181
    v_exp_f32 v182, v182
    v_exp_f32 v183, v183
    v_exp_f32 v184, v184
    v_exp_f32 v185, v185
    v_exp_f32 v186, v186
    v_exp_f32 v187, v187
    v_exp_f32 v188, v188
    v_exp_f32 v189, v189
    v_exp_f32 v190, v190
    v_exp_f32 v191, v191
    s_nop 0
    v_pk_add_f32 v[2:3], v[2:3], v[176:177]
    v_cvt_pk_bf16_f32 v176, v176, v177
    v_pk_add_f32 v[2:3], v[2:3], v[178:179]
    v_cvt_pk_bf16_f32 v177, v178, v179
    v_pk_add_f32 v[2:3], v[2:3], v[180:181]
    v_cvt_pk_bf16_f32 v178, v180, v181
    v_pk_add_f32 v[2:3], v[2:3], v[182:183]
    v_cvt_pk_bf16_f32 v179, v182, v183
    v_pk_add_f32 v[2:3], v[2:3], v[184:185]
    v_cvt_pk_bf16_f32 v180, v184, v185
    v_pk_add_f32 v[2:3], v[2:3], v[186:187]
    v_cvt_pk_bf16_f32 v181, v186, v187
    v_pk_add_f32 v[2:3], v[2:3], v[188:189]
    v_cvt_pk_bf16_f32 v182, v188, v189
    v_pk_add_f32 v[2:3], v[2:3], v[190:191]
    v_cvt_pk_bf16_f32 v183, v190, v191
    v_add_f32 v2, v2, v3
    v_mov_b32 v3, v2
    s_nop 1
    v_permlane32_swap_b32 v2, v3
    v_add_f32 v2, v2, v3
    v_rcp_f32 v2, v2
    s_nop 0
    ds_read_b64_tr_b16 v[20:21], v15 offset:24576
    ds_read_b64_tr_b16 v[22:23], v16 offset:24576
    ds_read_b64_tr_b16 v[24:25], v17 offset:24576
    ds_read_b64_tr_b16 v[26:27], v18 offset:24576
    ds_read_b64_tr_b16 v[28:29], v15 offset:26624
    ds_read_b64_tr_b16 v[30:31], v16 offset:26624
    ds_read_b64_tr_b16 v[32:33], v17 offset:26624
    ds_read_b64_tr_b16 v[34:35], v18 offset:26624
    s_waitcnt lgkmcnt(4)
    v_mfma_f32_32x32x16_bf16 v[192:207], v[20:23], v[48:51], 0
    v_mfma_f32_32x32x16_bf16 v[192:207], v[24:27], v[52:55], v[192:207]
    ds_read_b64_tr_b16 v[20:21], v15 offset:28672
    ds_read_b64_tr_b16 v[22:23], v16 offset:28672
    ds_read_b64_tr_b16 v[24:25], v17 offset:28672
    ds_read_b64_tr_b16 v[26:27], v18 offset:28672
    s_waitcnt lgkmcnt(4)
    v_mfma_f32_32x32x16_bf16 v[192:207], v[28:31], v[64:67], v[192:207]
    v_mfma_f32_32x32x16_bf16 v[192:207], v[32:35], v[68:71], v[192:207]
    ds_read_b64_tr_b16 v[28:29], v15 offset:30720
    ds_read_b64_tr_b16 v[30:31], v16 offset:30720
    ds_read_b64_tr_b16 v[32:33], v17 offset:30720
    ds_read_b64_tr_b16 v[34:35], v18 offset:30720
    s_waitcnt lgkmcnt(4)
    v_mfma_f32_32x32x16_bf16 v[192:207], v[20:23], v[80:83], v[192:207]
    v_mfma_f32_32x32x16_bf16 v[192:207], v[24:27], v[84:87], v[192:207]
    ds_read_b64_tr_b16 v[20:21], v15 offset:32768
    ds_read_b64_tr_b16 v[22:23], v16 offset:32768
    ds_read_b64_tr_b16 v[24:25], v17 offset:32768
    ds_read_b64_tr_b16 v[26:27], v18 offset:32768
    s_waitcnt lgkmcnt(4)
    v_mfma_f32_32x32x16_bf16 v[192:207], v[28:31], v[96:99], v[192:207]
    v_mfma_f32_32x32x16_bf16 v[192:207], v[32:35], v[100:103], v[192:207]
    ds_read_b64_tr_b16 v[28:29], v15 offset:34816
    ds_read_b64_tr_b16 v[30:31], v16 offset:34816
    ds_read_b64_tr_b16 v[32:33], v17 offset:34816
    ds_read_b64_tr_b16 v[34:35], v18 offset:34816
    s_waitcnt lgkmcnt(4)
    v_mfma_f32_32x32x16_bf16 v[192:207], v[20:23], v[112:115], v[192:207]
    v_mfma_f32_32x32x16_bf16 v[192:207], v[24:27], v[116:119], v[192:207]
    ds_read_b64_tr_b16 v[20:21], v15 offset:36864
    ds_read_b64_tr_b16 v[22:23], v16 offset:36864
    ds_read_b64_tr_b16 v[24:25], v17 offset:36864
    ds_read_b64_tr_b16 v[26:27], v18 offset:36864
    s_waitcnt lgkmcnt(4)
    v_mfma_f32_32x32x16_bf16 v[192:207], v[28:31], v[128:131], v[192:207]
    v_mfma_f32_32x32x16_bf16 v[192:207], v[32:35], v[132:135], v[192:207]
    ds_read_b64_tr_b16 v[28:29], v15 offset:38912
    ds_read_b64_tr_b16 v[30:31], v16 offset:38912
    ds_read_b64_tr_b16 v[32:33], v17 offset:38912
    ds_read_b64_tr_b16 v[34:35], v18 offset:38912
    s_waitcnt lgkmcnt(4)
    v_mfma_f32_32x32x16_bf16 v[192:207], v[20:23], v[144:147], v[192:207]
    v_mfma_f32_32x32x16_bf16 v[192:207], v[24:27], v[148:151], v[192:207]
    ds_read_b64_tr_b16 v[20:21], v15 offset:40960
    ds_read_b64_tr_b16 v[22:23], v16 offset:40960
    ds_read_b64_tr_b16 v[24:25], v17 offset:40960
    ds_read_b64_tr_b16 v[26:27], v18 offset:40960
    s_waitcnt lgkmcnt(4)
    v_mfma_f32_32x32x16_bf16 v[192:207], v[28:31], v[160:163], v[192:207]
    v_mfma_f32_32x32x16_bf16 v[192:207], v[32:35], v[164:167], v[192:207]
    s_waitcnt lgkmcnt(0)
    v_mfma_f32_32x32x16_bf16 v[192:207], v[20:23], v[176:179], v[192:207]
    v_mfma_f32_32x32x16_bf16 v[192:207], v[24:27], v[180:183], v[192:207]
    s_lshl_b32 s23, s21, 7
    s_lshl_b32 s24, s22, 5
    s_add_u32 s23, s23, s24
    v_and_b32 v1, 31, v0
    v_add_u32 v1, s23, v1
    v_lshlrev_b32 v1, 11, v1
    v_lshrrev_b32 v3, 5, v0
    v_lshlrev_b32 v3, 3, v3
    s_lshl_b32 s24, s20, 6
    v_add3_u32 v1, v1, v3, s24
    s_nop 7
    v_mul_f32 v192, v192, v2
    v_mul_f32 v193, v193, v2
    v_mul_f32 v194, v194, v2
    v_mul_f32 v195, v195, v2
    v_mul_f32 v196, v196, v2
    v_mul_f32 v197, v197, v2
    v_mul_f32 v198, v198, v2
    v_mul_f32 v199, v199, v2
    v_mul_f32 v200, v200, v2
    v_mul_f32 v201, v201, v2
    v_mul_f32 v202, v202, v2
    v_mul_f32 v203, v203, v2
    v_mul_f32 v204, v204, v2
    v_mul_f32 v205, v205, v2
    v_mul_f32 v206, v206, v2
    v_mul_f32 v207, v207, v2
    v_cvt_pk_bf16_f32 v208, v192, v193
    v_cvt_pk_bf16_f32 v209, v194, v195
    buffer_store_dwordx2 v[208:209], v1, s[8:11], 0 offen offset:0
    v_cvt_pk_bf16_f32 v210, v196, v197
    v_cvt_pk_bf16_f32 v211, v198, v199
    buffer_store_dwordx2 v[210:211], v1, s[8:11], 0 offen offset:16
    v_cvt_pk_bf16_f32 v212, v200, v201
    v_cvt_pk_bf16_f32 v213, v202, v203
    buffer_store_dwordx2 v[212:213], v1, s[8:11], 0 offen offset:32
    v_cvt_pk_bf16_f32 v214, v204, v205
    v_cvt_pk_bf16_f32 v215, v206, v207
    buffer_store_dwordx2 v[214:215], v1, s[8:11], 0 offen offset:48
    s_endpgm
attn_kernel_cs:
    s_cmp_ge_u32 s2, 112
    s_cbranch_scc1 attn_kernel_pf
    s_mov_b32 s20, s2
    s_cmp_lt_u32 s20, 56
    s_cselect_b32 s4, s72, s74
    s_cselect_b32 s5, s73, s75
    s_cselect_b32 s21, 0, 56
    s_and_b32 s5, s5, 0xffff
    s_mov_b32 s6, 7340032
    s_mov_b32 s7, 0x00020000
    s_sub_u32 s21, s20, s21
    s_add_u32 s8, s82, 50331648
    s_addc_u32 s9, s83, 0
    s_and_b32 s9, s9, 0xffff
    s_mov_b32 s10, 28672
    s_mov_b32 s11, 0x00020000
    v_lshrrev_b32 v1, 3, v0
    v_and_b32 v2, 7, v0
    s_mov_b32 s22, 7168
    v_mul_lo_u32 v1, v1, s22
    v_lshlrev_b32 v2, 4, v2
    s_lshl_b32 s22, s21, 7
    v_add3_u32 v1, v1, v2, s22
    v_mov_b32 v8, 0
    v_mov_b32 v9, 0
    v_mov_b32 v10, 0
    v_mov_b32 v11, 0
    v_mov_b32 v12, 0
    v_mov_b32 v13, 0
    v_mov_b32 v14, 0
    v_mov_b32 v15, 0
    v_add_u32 v2, 0, v1
    buffer_load_dwordx4 v[16:19], v2, s[4:7], 0 offen
    v_add_u32 v2, 229376, v1
    buffer_load_dwordx4 v[20:23], v2, s[4:7], 0 offen
    v_add_u32 v2, 458752, v1
    buffer_load_dwordx4 v[24:27], v2, s[4:7], 0 offen
    v_add_u32 v2, 688128, v1
    buffer_load_dwordx4 v[28:31], v2, s[4:7], 0 offen
    v_add_u32 v2, 917504, v1
    buffer_load_dwordx4 v[32:35], v2, s[4:7], 0 offen
    v_add_u32 v2, 1146880, v1
    buffer_load_dwordx4 v[36:39], v2, s[4:7], 0 offen
    v_add_u32 v2, 1376256, v1
    buffer_load_dwordx4 v[40:43], v2, s[4:7], 0 offen
    v_add_u32 v2, 1605632, v1
    buffer_load_dwordx4 v[44:47], v2, s[4:7], 0 offen
    v_add_u32 v2, 1835008, v1
    buffer_load_dwordx4 v[48:51], v2, s[4:7], 0 offen
    v_add_u32 v2, 2064384, v1
    buffer_load_dwordx4 v[52:55], v2, s[4:7], 0 offen
    v_add_u32 v2, 2293760, v1
    buffer_load_dwordx4 v[56:59], v2, s[4:7], 0 offen
    v_add_u32 v2, 2523136, v1
    buffer_load_dwordx4 v[60:63], v2, s[4:7], 0 offen
    v_add_u32 v2, 2752512, v1
    buffer_load_dwordx4 v[64:67], v2, s[4:7], 0 offen
    v_add_u32 v2, 2981888, v1
    buffer_load_dwordx4 v[68:71], v2, s[4:7], 0 offen
    v_add_u32 v2, 3211264, v1
    buffer_load_dwordx4 v[72:75], v2, s[4:7], 0 offen
    v_add_u32 v2, 3440640, v1
    buffer_load_dwordx4 v[76:79], v2, s[4:7], 0 offen
    v_add_u32 v2, 3670016, v1
    buffer_load_dwordx4 v[80:83], v2, s[4:7], 0 offen
    v_add_u32 v2, 3899392, v1
    buffer_load_dwordx4 v[84:87], v2, s[4:7], 0 offen
    v_add_u32 v2, 4128768, v1
    buffer_load_dwordx4 v[88:91], v2, s[4:7], 0 offen
    v_add_u32 v2, 4358144, v1
    buffer_load_dwordx4 v[92:95], v2, s[4:7], 0 offen
    v_add_u32 v2, 4587520, v1
    buffer_load_dwordx4 v[96:99], v2, s[4:7], 0 offen
    v_add_u32 v2, 4816896, v1
    buffer_load_dwordx4 v[100:103], v2, s[4:7], 0 offen
    v_add_u32 v2, 5046272, v1
    buffer_load_dwordx4 v[104:107], v2, s[4:7], 0 offen
    v_add_u32 v2, 5275648, v1
    buffer_load_dwordx4 v[108:111], v2, s[4:7], 0 offen
    v_add_u32 v2, 5505024, v1
    buffer_load_dwordx4 v[112:115], v2, s[4:7], 0 offen
    v_add_u32 v2, 5734400, v1
    buffer_load_dwordx4 v[116:119], v2, s[4:7], 0 offen
    v_add_u32 v2, 5963776, v1
    buffer_load_dwordx4 v[120:123], v2, s[4:7], 0 offen
    v_add_u32 v2, 6193152, v1
    buffer_load_dwordx4 v[124:127], v2, s[4:7], 0 offen
    v_add_u32 v2, 6422528, v1
    buffer_load_dwordx4 v[128:131], v2, s[4:7], 0 offen
    v_add_u32 v2, 6651904, v1
    buffer_load_dwordx4 v[132:135], v2, s[4:7], 0 offen
    v_add_u32 v2, 6881280, v1
    buffer_load_dwordx4 v[136:139], v2, s[4:7], 0 offen
    v_add_u32 v2, 7110656, v1
    buffer_load_dwordx4 v[140:143], v2, s[4:7], 0 offen
    s_waitcnt vmcnt(31)
    v_lshlrev_b32 v3, 16, v16
    v_and_b32 v4, 0xffff0000, v16
    v_add_f32 v8, v8, v3
    v_add_f32 v9, v9, v4
    v_lshlrev_b32 v3, 16, v17
    v_and_b32 v4, 0xffff0000, v17
    v_add_f32 v10, v10, v3
    v_add_f32 v11, v11, v4
    v_lshlrev_b32 v3, 16, v18
    v_and_b32 v4, 0xffff0000, v18
    v_add_f32 v12, v12, v3
    v_add_f32 v13, v13, v4
    v_lshlrev_b32 v3, 16, v19
    v_and_b32 v4, 0xffff0000, v19
    v_add_f32 v14, v14, v3
    v_add_f32 v15, v15, v4
    s_waitcnt vmcnt(30)
    v_lshlrev_b32 v3, 16, v20
    v_and_b32 v4, 0xffff0000, v20
    v_add_f32 v8, v8, v3
    v_add_f32 v9, v9, v4
    v_lshlrev_b32 v3, 16, v21
    v_and_b32 v4, 0xffff0000, v21
    v_add_f32 v10, v10, v3
    v_add_f32 v11, v11, v4
    v_lshlrev_b32 v3, 16, v22
    v_and_b32 v4, 0xffff0000, v22
    v_add_f32 v12, v12, v3
    v_add_f32 v13, v13, v4
    v_lshlrev_b32 v3, 16, v23
    v_and_b32 v4, 0xffff0000, v23
    v_add_f32 v14, v14, v3
    v_add_f32 v15, v15, v4
    s_waitcnt vmcnt(29)
    v_lshlrev_b32 v3, 16, v24
    v_and_b32 v4, 0xffff0000, v24
    v_add_f32 v8, v8, v3
    v_add_f32 v9, v9, v4
    v_lshlrev_b32 v3, 16, v25
    v_and_b32 v4, 0xffff0000, v25
    v_add_f32 v10, v10, v3
    v_add_f32 v11, v11, v4
    v_lshlrev_b32 v3, 16, v26
    v_and_b32 v4, 0xffff0000, v26
    v_add_f32 v12, v12, v3
    v_add_f32 v13, v13, v4
    v_lshlrev_b32 v3, 16, v27
    v_and_b32 v4, 0xffff0000, v27
    v_add_f32 v14, v14, v3
    v_add_f32 v15, v15, v4
    s_waitcnt vmcnt(28)
    v_lshlrev_b32 v3, 16, v28
    v_and_b32 v4, 0xffff0000, v28
    v_add_f32 v8, v8, v3
    v_add_f32 v9, v9, v4
    v_lshlrev_b32 v3, 16, v29
    v_and_b32 v4, 0xffff0000, v29
    v_add_f32 v10, v10, v3
    v_add_f32 v11, v11, v4
    v_lshlrev_b32 v3, 16, v30
    v_and_b32 v4, 0xffff0000, v30
    v_add_f32 v12, v12, v3
    v_add_f32 v13, v13, v4
    v_lshlrev_b32 v3, 16, v31
    v_and_b32 v4, 0xffff0000, v31
    v_add_f32 v14, v14, v3
    v_add_f32 v15, v15, v4
    s_waitcnt vmcnt(27)
    v_lshlrev_b32 v3, 16, v32
    v_and_b32 v4, 0xffff0000, v32
    v_add_f32 v8, v8, v3
    v_add_f32 v9, v9, v4
    v_lshlrev_b32 v3, 16, v33
    v_and_b32 v4, 0xffff0000, v33
    v_add_f32 v10, v10, v3
    v_add_f32 v11, v11, v4
    v_lshlrev_b32 v3, 16, v34
    v_and_b32 v4, 0xffff0000, v34
    v_add_f32 v12, v12, v3
    v_add_f32 v13, v13, v4
    v_lshlrev_b32 v3, 16, v35
    v_and_b32 v4, 0xffff0000, v35
    v_add_f32 v14, v14, v3
    v_add_f32 v15, v15, v4
    s_waitcnt vmcnt(26)
    v_lshlrev_b32 v3, 16, v36
    v_and_b32 v4, 0xffff0000, v36
    v_add_f32 v8, v8, v3
    v_add_f32 v9, v9, v4
    v_lshlrev_b32 v3, 16, v37
    v_and_b32 v4, 0xffff0000, v37
    v_add_f32 v10, v10, v3
    v_add_f32 v11, v11, v4
    v_lshlrev_b32 v3, 16, v38
    v_and_b32 v4, 0xffff0000, v38
    v_add_f32 v12, v12, v3
    v_add_f32 v13, v13, v4
    v_lshlrev_b32 v3, 16, v39
    v_and_b32 v4, 0xffff0000, v39
    v_add_f32 v14, v14, v3
    v_add_f32 v15, v15, v4
    s_waitcnt vmcnt(25)
    v_lshlrev_b32 v3, 16, v40
    v_and_b32 v4, 0xffff0000, v40
    v_add_f32 v8, v8, v3
    v_add_f32 v9, v9, v4
    v_lshlrev_b32 v3, 16, v41
    v_and_b32 v4, 0xffff0000, v41
    v_add_f32 v10, v10, v3
    v_add_f32 v11, v11, v4
    v_lshlrev_b32 v3, 16, v42
    v_and_b32 v4, 0xffff0000, v42
    v_add_f32 v12, v12, v3
    v_add_f32 v13, v13, v4
    v_lshlrev_b32 v3, 16, v43
    v_and_b32 v4, 0xffff0000, v43
    v_add_f32 v14, v14, v3
    v_add_f32 v15, v15, v4
    s_waitcnt vmcnt(24)
    v_lshlrev_b32 v3, 16, v44
    v_and_b32 v4, 0xffff0000, v44
    v_add_f32 v8, v8, v3
    v_add_f32 v9, v9, v4
    v_lshlrev_b32 v3, 16, v45
    v_and_b32 v4, 0xffff0000, v45
    v_add_f32 v10, v10, v3
    v_add_f32 v11, v11, v4
    v_lshlrev_b32 v3, 16, v46
    v_and_b32 v4, 0xffff0000, v46
    v_add_f32 v12, v12, v3
    v_add_f32 v13, v13, v4
    v_lshlrev_b32 v3, 16, v47
    v_and_b32 v4, 0xffff0000, v47
    v_add_f32 v14, v14, v3
    v_add_f32 v15, v15, v4
    s_waitcnt vmcnt(23)
    v_lshlrev_b32 v3, 16, v48
    v_and_b32 v4, 0xffff0000, v48
    v_add_f32 v8, v8, v3
    v_add_f32 v9, v9, v4
    v_lshlrev_b32 v3, 16, v49
    v_and_b32 v4, 0xffff0000, v49
    v_add_f32 v10, v10, v3
    v_add_f32 v11, v11, v4
    v_lshlrev_b32 v3, 16, v50
    v_and_b32 v4, 0xffff0000, v50
    v_add_f32 v12, v12, v3
    v_add_f32 v13, v13, v4
    v_lshlrev_b32 v3, 16, v51
    v_and_b32 v4, 0xffff0000, v51
    v_add_f32 v14, v14, v3
    v_add_f32 v15, v15, v4
    s_waitcnt vmcnt(22)
    v_lshlrev_b32 v3, 16, v52
    v_and_b32 v4, 0xffff0000, v52
    v_add_f32 v8, v8, v3
    v_add_f32 v9, v9, v4
    v_lshlrev_b32 v3, 16, v53
    v_and_b32 v4, 0xffff0000, v53
    v_add_f32 v10, v10, v3
    v_add_f32 v11, v11, v4
    v_lshlrev_b32 v3, 16, v54
    v_and_b32 v4, 0xffff0000, v54
    v_add_f32 v12, v12, v3
    v_add_f32 v13, v13, v4
    v_lshlrev_b32 v3, 16, v55
    v_and_b32 v4, 0xffff0000, v55
    v_add_f32 v14, v14, v3
    v_add_f32 v15, v15, v4
    s_waitcnt vmcnt(21)
    v_lshlrev_b32 v3, 16, v56
    v_and_b32 v4, 0xffff0000, v56
    v_add_f32 v8, v8, v3
    v_add_f32 v9, v9, v4
    v_lshlrev_b32 v3, 16, v57
    v_and_b32 v4, 0xffff0000, v57
    v_add_f32 v10, v10, v3
    v_add_f32 v11, v11, v4
    v_lshlrev_b32 v3, 16, v58
    v_and_b32 v4, 0xffff0000, v58
    v_add_f32 v12, v12, v3
    v_add_f32 v13, v13, v4
    v_lshlrev_b32 v3, 16, v59
    v_and_b32 v4, 0xffff0000, v59
    v_add_f32 v14, v14, v3
    v_add_f32 v15, v15, v4
    s_waitcnt vmcnt(20)
    v_lshlrev_b32 v3, 16, v60
    v_and_b32 v4, 0xffff0000, v60
    v_add_f32 v8, v8, v3
    v_add_f32 v9, v9, v4
    v_lshlrev_b32 v3, 16, v61
    v_and_b32 v4, 0xffff0000, v61
    v_add_f32 v10, v10, v3
    v_add_f32 v11, v11, v4
    v_lshlrev_b32 v3, 16, v62
    v_and_b32 v4, 0xffff0000, v62
    v_add_f32 v12, v12, v3
    v_add_f32 v13, v13, v4
    v_lshlrev_b32 v3, 16, v63
    v_and_b32 v4, 0xffff0000, v63
    v_add_f32 v14, v14, v3
    v_add_f32 v15, v15, v4
    s_waitcnt vmcnt(19)
    v_lshlrev_b32 v3, 16, v64
    v_and_b32 v4, 0xffff0000, v64
    v_add_f32 v8, v8, v3
    v_add_f32 v9, v9, v4
    v_lshlrev_b32 v3, 16, v65
    v_and_b32 v4, 0xffff0000, v65
    v_add_f32 v10, v10, v3
    v_add_f32 v11, v11, v4
    v_lshlrev_b32 v3, 16, v66
    v_and_b32 v4, 0xffff0000, v66
    v_add_f32 v12, v12, v3
    v_add_f32 v13, v13, v4
    v_lshlrev_b32 v3, 16, v67
    v_and_b32 v4, 0xffff0000, v67
    v_add_f32 v14, v14, v3
    v_add_f32 v15, v15, v4
    s_waitcnt vmcnt(18)
    v_lshlrev_b32 v3, 16, v68
    v_and_b32 v4, 0xffff0000, v68
    v_add_f32 v8, v8, v3
    v_add_f32 v9, v9, v4
    v_lshlrev_b32 v3, 16, v69
    v_and_b32 v4, 0xffff0000, v69
    v_add_f32 v10, v10, v3
    v_add_f32 v11, v11, v4
    v_lshlrev_b32 v3, 16, v70
    v_and_b32 v4, 0xffff0000, v70
    v_add_f32 v12, v12, v3
    v_add_f32 v13, v13, v4
    v_lshlrev_b32 v3, 16, v71
    v_and_b32 v4, 0xffff0000, v71
    v_add_f32 v14, v14, v3
    v_add_f32 v15, v15, v4
    s_waitcnt vmcnt(17)
    v_lshlrev_b32 v3, 16, v72
    v_and_b32 v4, 0xffff0000, v72
    v_add_f32 v8, v8, v3
    v_add_f32 v9, v9, v4
    v_lshlrev_b32 v3, 16, v73
    v_and_b32 v4, 0xffff0000, v73
    v_add_f32 v10, v10, v3
    v_add_f32 v11, v11, v4
    v_lshlrev_b32 v3, 16, v74
    v_and_b32 v4, 0xffff0000, v74
    v_add_f32 v12, v12, v3
    v_add_f32 v13, v13, v4
    v_lshlrev_b32 v3, 16, v75
    v_and_b32 v4, 0xffff0000, v75
    v_add_f32 v14, v14, v3
    v_add_f32 v15, v15, v4
    s_waitcnt vmcnt(16)
    v_lshlrev_b32 v3, 16, v76
    v_and_b32 v4, 0xffff0000, v76
    v_add_f32 v8, v8, v3
    v_add_f32 v9, v9, v4
    v_lshlrev_b32 v3, 16, v77
    v_and_b32 v4, 0xffff0000, v77
    v_add_f32 v10, v10, v3
    v_add_f32 v11, v11, v4
    v_lshlrev_b32 v3, 16, v78
    v_and_b32 v4, 0xffff0000, v78
    v_add_f32 v12, v12, v3
    v_add_f32 v13, v13, v4
    v_lshlrev_b32 v3, 16, v79
    v_and_b32 v4, 0xffff0000, v79
    v_add_f32 v14, v14, v3
    v_add_f32 v15, v15, v4
    s_waitcnt vmcnt(15)
    v_lshlrev_b32 v3, 16, v80
    v_and_b32 v4, 0xffff0000, v80
    v_add_f32 v8, v8, v3
    v_add_f32 v9, v9, v4
    v_lshlrev_b32 v3, 16, v81
    v_and_b32 v4, 0xffff0000, v81
    v_add_f32 v10, v10, v3
    v_add_f32 v11, v11, v4
    v_lshlrev_b32 v3, 16, v82
    v_and_b32 v4, 0xffff0000, v82
    v_add_f32 v12, v12, v3
    v_add_f32 v13, v13, v4
    v_lshlrev_b32 v3, 16, v83
    v_and_b32 v4, 0xffff0000, v83
    v_add_f32 v14, v14, v3
    v_add_f32 v15, v15, v4
    s_waitcnt vmcnt(14)
    v_lshlrev_b32 v3, 16, v84
    v_and_b32 v4, 0xffff0000, v84
    v_add_f32 v8, v8, v3
    v_add_f32 v9, v9, v4
    v_lshlrev_b32 v3, 16, v85
    v_and_b32 v4, 0xffff0000, v85
    v_add_f32 v10, v10, v3
    v_add_f32 v11, v11, v4
    v_lshlrev_b32 v3, 16, v86
    v_and_b32 v4, 0xffff0000, v86
    v_add_f32 v12, v12, v3
    v_add_f32 v13, v13, v4
    v_lshlrev_b32 v3, 16, v87
    v_and_b32 v4, 0xffff0000, v87
    v_add_f32 v14, v14, v3
    v_add_f32 v15, v15, v4
    s_waitcnt vmcnt(13)
    v_lshlrev_b32 v3, 16, v88
    v_and_b32 v4, 0xffff0000, v88
    v_add_f32 v8, v8, v3
    v_add_f32 v9, v9, v4
    v_lshlrev_b32 v3, 16, v89
    v_and_b32 v4, 0xffff0000, v89
    v_add_f32 v10, v10, v3
    v_add_f32 v11, v11, v4
    v_lshlrev_b32 v3, 16, v90
    v_and_b32 v4, 0xffff0000, v90
    v_add_f32 v12, v12, v3
    v_add_f32 v13, v13, v4
    v_lshlrev_b32 v3, 16, v91
    v_and_b32 v4, 0xffff0000, v91
    v_add_f32 v14, v14, v3
    v_add_f32 v15, v15, v4
    s_waitcnt vmcnt(12)
    v_lshlrev_b32 v3, 16, v92
    v_and_b32 v4, 0xffff0000, v92
    v_add_f32 v8, v8, v3
    v_add_f32 v9, v9, v4
    v_lshlrev_b32 v3, 16, v93
    v_and_b32 v4, 0xffff0000, v93
    v_add_f32 v10, v10, v3
    v_add_f32 v11, v11, v4
    v_lshlrev_b32 v3, 16, v94
    v_and_b32 v4, 0xffff0000, v94
    v_add_f32 v12, v12, v3
    v_add_f32 v13, v13, v4
    v_lshlrev_b32 v3, 16, v95
    v_and_b32 v4, 0xffff0000, v95
    v_add_f32 v14, v14, v3
    v_add_f32 v15, v15, v4
    s_waitcnt vmcnt(11)
    v_lshlrev_b32 v3, 16, v96
    v_and_b32 v4, 0xffff0000, v96
    v_add_f32 v8, v8, v3
    v_add_f32 v9, v9, v4
    v_lshlrev_b32 v3, 16, v97
    v_and_b32 v4, 0xffff0000, v97
    v_add_f32 v10, v10, v3
    v_add_f32 v11, v11, v4
    v_lshlrev_b32 v3, 16, v98
    v_and_b32 v4, 0xffff0000, v98
    v_add_f32 v12, v12, v3
    v_add_f32 v13, v13, v4
    v_lshlrev_b32 v3, 16, v99
    v_and_b32 v4, 0xffff0000, v99
    v_add_f32 v14, v14, v3
    v_add_f32 v15, v15, v4
    s_waitcnt vmcnt(10)
    v_lshlrev_b32 v3, 16, v100
    v_and_b32 v4, 0xffff0000, v100
    v_add_f32 v8, v8, v3
    v_add_f32 v9, v9, v4
    v_lshlrev_b32 v3, 16, v101
    v_and_b32 v4, 0xffff0000, v101
    v_add_f32 v10, v10, v3
    v_add_f32 v11, v11, v4
    v_lshlrev_b32 v3, 16, v102
    v_and_b32 v4, 0xffff0000, v102
    v_add_f32 v12, v12, v3
    v_add_f32 v13, v13, v4
    v_lshlrev_b32 v3, 16, v103
    v_and_b32 v4, 0xffff0000, v103
    v_add_f32 v14, v14, v3
    v_add_f32 v15, v15, v4
    s_waitcnt vmcnt(9)
    v_lshlrev_b32 v3, 16, v104
    v_and_b32 v4, 0xffff0000, v104
    v_add_f32 v8, v8, v3
    v_add_f32 v9, v9, v4
    v_lshlrev_b32 v3, 16, v105
    v_and_b32 v4, 0xffff0000, v105
    v_add_f32 v10, v10, v3
    v_add_f32 v11, v11, v4
    v_lshlrev_b32 v3, 16, v106
    v_and_b32 v4, 0xffff0000, v106
    v_add_f32 v12, v12, v3
    v_add_f32 v13, v13, v4
    v_lshlrev_b32 v3, 16, v107
    v_and_b32 v4, 0xffff0000, v107
    v_add_f32 v14, v14, v3
    v_add_f32 v15, v15, v4
    s_waitcnt vmcnt(8)
    v_lshlrev_b32 v3, 16, v108
    v_and_b32 v4, 0xffff0000, v108
    v_add_f32 v8, v8, v3
    v_add_f32 v9, v9, v4
    v_lshlrev_b32 v3, 16, v109
    v_and_b32 v4, 0xffff0000, v109
    v_add_f32 v10, v10, v3
    v_add_f32 v11, v11, v4
    v_lshlrev_b32 v3, 16, v110
    v_and_b32 v4, 0xffff0000, v110
    v_add_f32 v12, v12, v3
    v_add_f32 v13, v13, v4
    v_lshlrev_b32 v3, 16, v111
    v_and_b32 v4, 0xffff0000, v111
    v_add_f32 v14, v14, v3
    v_add_f32 v15, v15, v4
    s_waitcnt vmcnt(7)
    v_lshlrev_b32 v3, 16, v112
    v_and_b32 v4, 0xffff0000, v112
    v_add_f32 v8, v8, v3
    v_add_f32 v9, v9, v4
    v_lshlrev_b32 v3, 16, v113
    v_and_b32 v4, 0xffff0000, v113
    v_add_f32 v10, v10, v3
    v_add_f32 v11, v11, v4
    v_lshlrev_b32 v3, 16, v114
    v_and_b32 v4, 0xffff0000, v114
    v_add_f32 v12, v12, v3
    v_add_f32 v13, v13, v4
    v_lshlrev_b32 v3, 16, v115
    v_and_b32 v4, 0xffff0000, v115
    v_add_f32 v14, v14, v3
    v_add_f32 v15, v15, v4
    s_waitcnt vmcnt(6)
    v_lshlrev_b32 v3, 16, v116
    v_and_b32 v4, 0xffff0000, v116
    v_add_f32 v8, v8, v3
    v_add_f32 v9, v9, v4
    v_lshlrev_b32 v3, 16, v117
    v_and_b32 v4, 0xffff0000, v117
    v_add_f32 v10, v10, v3
    v_add_f32 v11, v11, v4
    v_lshlrev_b32 v3, 16, v118
    v_and_b32 v4, 0xffff0000, v118
    v_add_f32 v12, v12, v3
    v_add_f32 v13, v13, v4
    v_lshlrev_b32 v3, 16, v119
    v_and_b32 v4, 0xffff0000, v119
    v_add_f32 v14, v14, v3
    v_add_f32 v15, v15, v4
    s_waitcnt vmcnt(5)
    v_lshlrev_b32 v3, 16, v120
    v_and_b32 v4, 0xffff0000, v120
    v_add_f32 v8, v8, v3
    v_add_f32 v9, v9, v4
    v_lshlrev_b32 v3, 16, v121
    v_and_b32 v4, 0xffff0000, v121
    v_add_f32 v10, v10, v3
    v_add_f32 v11, v11, v4
    v_lshlrev_b32 v3, 16, v122
    v_and_b32 v4, 0xffff0000, v122
    v_add_f32 v12, v12, v3
    v_add_f32 v13, v13, v4
    v_lshlrev_b32 v3, 16, v123
    v_and_b32 v4, 0xffff0000, v123
    v_add_f32 v14, v14, v3
    v_add_f32 v15, v15, v4
    s_waitcnt vmcnt(4)
    v_lshlrev_b32 v3, 16, v124
    v_and_b32 v4, 0xffff0000, v124
    v_add_f32 v8, v8, v3
    v_add_f32 v9, v9, v4
    v_lshlrev_b32 v3, 16, v125
    v_and_b32 v4, 0xffff0000, v125
    v_add_f32 v10, v10, v3
    v_add_f32 v11, v11, v4
    v_lshlrev_b32 v3, 16, v126
    v_and_b32 v4, 0xffff0000, v126
    v_add_f32 v12, v12, v3
    v_add_f32 v13, v13, v4
    v_lshlrev_b32 v3, 16, v127
    v_and_b32 v4, 0xffff0000, v127
    v_add_f32 v14, v14, v3
    v_add_f32 v15, v15, v4
    s_waitcnt vmcnt(3)
    v_lshlrev_b32 v3, 16, v128
    v_and_b32 v4, 0xffff0000, v128
    v_add_f32 v8, v8, v3
    v_add_f32 v9, v9, v4
    v_lshlrev_b32 v3, 16, v129
    v_and_b32 v4, 0xffff0000, v129
    v_add_f32 v10, v10, v3
    v_add_f32 v11, v11, v4
    v_lshlrev_b32 v3, 16, v130
    v_and_b32 v4, 0xffff0000, v130
    v_add_f32 v12, v12, v3
    v_add_f32 v13, v13, v4
    v_lshlrev_b32 v3, 16, v131
    v_and_b32 v4, 0xffff0000, v131
    v_add_f32 v14, v14, v3
    v_add_f32 v15, v15, v4
    s_waitcnt vmcnt(2)
    v_lshlrev_b32 v3, 16, v132
    v_and_b32 v4, 0xffff0000, v132
    v_add_f32 v8, v8, v3
    v_add_f32 v9, v9, v4
    v_lshlrev_b32 v3, 16, v133
    v_and_b32 v4, 0xffff0000, v133
    v_add_f32 v10, v10, v3
    v_add_f32 v11, v11, v4
    v_lshlrev_b32 v3, 16, v134
    v_and_b32 v4, 0xffff0000, v134
    v_add_f32 v12, v12, v3
    v_add_f32 v13, v13, v4
    v_lshlrev_b32 v3, 16, v135
    v_and_b32 v4, 0xffff0000, v135
    v_add_f32 v14, v14, v3
    v_add_f32 v15, v15, v4
    s_waitcnt vmcnt(1)
    v_lshlrev_b32 v3, 16, v136
    v_and_b32 v4, 0xffff0000, v136
    v_add_f32 v8, v8, v3
    v_add_f32 v9, v9, v4
    v_lshlrev_b32 v3, 16, v137
    v_and_b32 v4, 0xffff0000, v137
    v_add_f32 v10, v10, v3
    v_add_f32 v11, v11, v4
    v_lshlrev_b32 v3, 16, v138
    v_and_b32 v4, 0xffff0000, v138
    v_add_f32 v12, v12, v3
    v_add_f32 v13, v13, v4
    v_lshlrev_b32 v3, 16, v139
    v_and_b32 v4, 0xffff0000, v139
    v_add_f32 v14, v14, v3
    v_add_f32 v15, v15, v4
    s_waitcnt vmcnt(0)
    v_lshlrev_b32 v3, 16, v140
    v_and_b32 v4, 0xffff0000, v140
    v_add_f32 v8, v8, v3
    v_add_f32 v9, v9, v4
    v_lshlrev_b32 v3, 16, v141
    v_and_b32 v4, 0xffff0000, v141
    v_add_f32 v10, v10, v3
    v_add_f32 v11, v11, v4
    v_lshlrev_b32 v3, 16, v142
    v_and_b32 v4, 0xffff0000, v142
    v_add_f32 v12, v12, v3
    v_add_f32 v13, v13, v4
    v_lshlrev_b32 v3, 16, v143
    v_and_b32 v4, 0xffff0000, v143
    v_add_f32 v14, v14, v3
    v_add_f32 v15, v15, v4
    v_lshlrev_b32 v2, 5, v0
    ds_write_b128 v2, v[8:11]
    ds_write_b128 v2, v[12:15] offset:16
    s_waitcnt lgkmcnt(0)
    s_barrier
    v_cmp_gt_u32 vcc, 64, v0
    s_and_saveexec_b64 s[24:25], vcc
    s_cbranch_execz attn_kernel_end
    v_lshlrev_b32 v2, 2, v0
    ds_read_b32 v16, v2 offset:0
    ds_read_b32 v17, v2 offset:256
    ds_read_b32 v18, v2 offset:512
    ds_read_b32 v19, v2 offset:768
    ds_read_b32 v20, v2 offset:1024
    ds_read_b32 v21, v2 offset:1280
    ds_read_b32 v22, v2 offset:1536
    ds_read_b32 v23, v2 offset:1792
    ds_read_b32 v24, v2 offset:2048
    ds_read_b32 v25, v2 offset:2304
    ds_read_b32 v26, v2 offset:2560
    ds_read_b32 v27, v2 offset:2816
    ds_read_b32 v28, v2 offset:3072
    ds_read_b32 v29, v2 offset:3328
    ds_read_b32 v30, v2 offset:3584
    ds_read_b32 v31, v2 offset:3840
    ds_read_b32 v32, v2 offset:4096
    ds_read_b32 v33, v2 offset:4352
    ds_read_b32 v34, v2 offset:4608
    ds_read_b32 v35, v2 offset:4864
    ds_read_b32 v36, v2 offset:5120
    ds_read_b32 v37, v2 offset:5376
    ds_read_b32 v38, v2 offset:5632
    ds_read_b32 v39, v2 offset:5888
    ds_read_b32 v40, v2 offset:6144
    ds_read_b32 v41, v2 offset:6400
    ds_read_b32 v42, v2 offset:6656
    ds_read_b32 v43, v2 offset:6912
    ds_read_b32 v44, v2 offset:7168
    ds_read_b32 v45, v2 offset:7424
    ds_read_b32 v46, v2 offset:7680
    ds_read_b32 v47, v2 offset:7936
    s_waitcnt lgkmcnt(0)
    v_add_f32 v16, v16, v17
    v_add_f32 v16, v16, v18
    v_add_f32 v16, v16, v19
    v_add_f32 v16, v16, v20
    v_add_f32 v16, v16, v21
    v_add_f32 v16, v16, v22
    v_add_f32 v16, v16, v23
    v_add_f32 v16, v16, v24
    v_add_f32 v16, v16, v25
    v_add_f32 v16, v16, v26
    v_add_f32 v16, v16, v27
    v_add_f32 v16, v16, v28
    v_add_f32 v16, v16, v29
    v_add_f32 v16, v16, v30
    v_add_f32 v16, v16, v31
    v_add_f32 v16, v16, v32
    v_add_f32 v16, v16, v33
    v_add_f32 v16, v16, v34
    v_add_f32 v16, v16, v35
    v_add_f32 v16, v16, v36
    v_add_f32 v16, v16, v37
    v_add_f32 v16, v16, v38
    v_add_f32 v16, v16, v39
    v_add_f32 v16, v16, v40
    v_add_f32 v16, v16, v41
    v_add_f32 v16, v16, v42
    v_add_f32 v16, v16, v43
    v_add_f32 v16, v16, v44
    v_add_f32 v16, v16, v45
    v_add_f32 v16, v16, v46
    v_add_f32 v16, v16, v47
    s_lshl_b32 s22, s20, 8
    v_add_u32 v2, s22, v2
    buffer_store_dword v16, v2, s[8:11], 0 offen
    s_endpgm
attn_kernel_pf:
    s_sub_u32 s20, s2, 112
    s_cmp_lt_u32 s20, 0
    s_cselect_b32 s4, s76, s68
    s_cselect_b32 s5, s77, s69
    s_mov_b32 s23, 2097152
    s_cselect_b32 s6, 7340032, s23
    s_cselect_b32 s21, 0, 0
    s_mov_b32 s22, 65536
    s_and_b32 s5, s5, 0xffff
    s_mov_b32 s7, 0x00020000
    s_sub_u32 s21, s20, s21
    s_mul_i32 s21, s21, s22
    v_lshlrev_b32 v1, 4, v0
    v_add_u32 v1, s21, v1
    buffer_load_dwordx4 v[8:11], v1, s[4:7], 0 offen
    v_add_u32 v1, 4096, v1
    buffer_load_dwordx4 v[12:15], v1, s[4:7], 0 offen
    v_add_u32 v1, 4096, v1
    buffer_load_dwordx4 v[16:19], v1, s[4:7], 0 offen
    v_add_u32 v1, 4096, v1
    buffer_load_dwordx4 v[20:23], v1, s[4:7], 0 offen
    v_add_u32 v1, 4096, v1
    buffer_load_dwordx4 v[24:27], v1, s[4:7], 0 offen
    v_add_u32 v1, 4096, v1
    buffer_load_dwordx4 v[28:31], v1, s[4:7], 0 offen
    v_add_u32 v1, 4096, v1
    buffer_load_dwordx4 v[32:35], v1, s[4:7], 0 offen
    v_add_u32 v1, 4096, v1
    buffer_load_dwordx4 v[36:39], v1, s[4:7], 0 offen
    v_add_u32 v1, 4096, v1
    buffer_load_dwordx4 v[40:43], v1, s[4:7], 0 offen
    v_add_u32 v1, 4096, v1
    buffer_load_dwordx4 v[44:47], v1, s[4:7], 0 offen
    v_add_u32 v1, 4096, v1
    buffer_load_dwordx4 v[48:51], v1, s[4:7], 0 offen
    v_add_u32 v1, 4096, v1
    buffer_load_dwordx4 v[52:55], v1, s[4:7], 0 offen
    v_add_u32 v1, 4096, v1
    buffer_load_dwordx4 v[56:59], v1, s[4:7], 0 offen
    v_add_u32 v1, 4096, v1
    buffer_load_dwordx4 v[60:63], v1, s[4:7], 0 offen
    v_add_u32 v1, 4096, v1
    buffer_load_dwordx4 v[64:67], v1, s[4:7], 0 offen
    v_add_u32 v1, 4096, v1
    buffer_load_dwordx4 v[68:71], v1, s[4:7], 0 offen
    v_add_u32 v1, 4096, v1
    s_waitcnt vmcnt(0)
attn_kernel_end:
    s_endpgm
.globl g2_kernel
.p2align 8
.type g2_kernel,@function
g2_kernel:
    s_cmp_ge_u32 s2, 256
    s_cbranch_scc1 g2_kernel_end
    s_load_dwordx16 s[64:79], s[0:1], 0
    s_load_dwordx4 s[80:83], s[0:1], 64
    s_waitcnt lgkmcnt(0)
    s_add_u32 s4, s82, 16777216
    s_addc_u32 s5, s83, 0
    s_and_b32 s5, s5, 0xffff
    s_mov_b32 s6, 4194304
    s_mov_b32 s7, 0x00020000
    s_mov_b32 s8, s68
    s_and_b32 s9, s69, 0xffff
    s_mov_b32 s10, 2097152
    s_mov_b32 s11, 0x00020000
    s_and_b32 s25, s2, 7
    s_lshr_b32 s26, s2, 3
    s_and_b32 s20, s25, 3
    s_mul_i32 s20, s20, 4
    s_and_b32 s27, s26, 3
    s_add_u32 s20, s20, s27
    s_lshr_b32 s21, s25, 2
    s_mul_i32 s21, s21, 8
    s_lshr_b32 s27, s26, 2
    s_add_u32 s21, s21, s27
    v_lshrrev_b32 v1, 6, v0
    s_nop 0
    v_readfirstlane_b32 s19, v1
    s_and_b32 s23, s19, 1
    s_lshr_b32 s24, s19, 1
    s_and_b32 s24, s24, 1
    s_sub_u32 s22, s19, 4
    s_and_b32 s22, s22, 3
    v_and_b32 v0, 63, v0
    v_lshrrev_b32 v1, 3, v0
    v_and_b32 v32, 7, v0
    v_xor_b32 v32, v32, v1
    v_lshlrev_b32 v32, 4, v32
    s_mul_i32 s25, s22, 32
    s_mul_i32 s26, s20, 128
    s_add_u32 s25, s25, s26
    v_add_u32 v1, s25, v1
    s_mov_b32 s26, 2048
    v_mul_lo_u32 v1, v1, s26
    v_add_u32 v2, v1, v32
    v_add_u32 v3, 16384, v2
    v_add_u32 v4, 32768, v2
    v_add_u32 v5, 49152, v2
    s_mul_i32 s25, s22, 16
    s_add_u32 s25, s25, 0
    v_lshrrev_b32 v1, 3, v0
    v_add_u32 v1, s25, v1
    v_bfe_u32 v32, v1, 1, 1
    v_lshrrev_b32 v33, 2, v1
    v_and_b32 v33, 2, v33
    v_or_b32 v32, v32, v33
    v_lshlrev_b32 v32, 1, v32
    v_and_b32 v33, 7, v0
    v_xor_b32 v32, v32, v33
    v_lshlrev_b32 v32, 4, v32
    s_mov_b32 s26, 2048
    v_mul_lo_u32 v1, v1, s26
    v_add_u32 v1, v1, v32
    s_mul_i32 s26, s21, 128
    v_add_u32 v6, s26, v1
    s_mul_i32 s25, s22, 16
    s_add_u32 s25, s25, 8
    v_lshrrev_b32 v1, 3, v0
    v_add_u32 v1, s25, v1
    v_bfe_u32 v32, v1, 1, 1
    v_lshrrev_b32 v33, 2, v1
    v_and_b32 v33, 2, v33
    v_or_b32 v32, v32, v33
    v_lshlrev_b32 v32, 1, v32
    v_and_b32 v33, 7, v0
    v_xor_b32 v32, v32, v33
    v_lshlrev_b32 v32, 4, v32
    s_mov_b32 s26, 2048
    v_mul_lo_u32 v1, v1, s26
    v_add_u32 v1, v1, v32
    s_mul_i32 s26, s21, 128
    v_add_u32 v7, s26, v1
    s_mov_b32 s30, 0
    s_mov_b32 s31, 0
    s_mov_b32 s34, 0
    s_mul_i32 s35, s22, 4096
    s_mul_i32 s44, s22, 2048
    s_add_u32 s44, s44, 16384
    s_mov_b32 s37, 0
    s_cmp_lt_u32 s19, 4
    s_cbranch_scc1 g2_kernel_comp
    s_add_u32 s36, s34, s35
    s_mov_b32 m0, s36
    s_nop 0
    buffer_load_dwordx4 v2, s[4:7], s30 offen lds
    s_add_u32 m0, s36, 1024
    s_nop 0
    buffer_load_dwordx4 v3, s[4:7], s30 offen lds
    s_add_u32 m0, s36, 2048
    s_nop 0
    buffer_load_dwordx4 v4, s[4:7], s30 offen lds
    s_add_u32 m0, s36, 3072
    s_nop 0
    buffer_load_dwordx4 v5, s[4:7], s30 offen lds
    s_add_u32 s36, s34, s44
    s_mov_b32 m0, s36
    s_nop 0
    buffer_load_dwordx4 v6, s[8:11], s31 offen lds
    s_add_u32 m0, s36, 1024
    s_nop 0
    buffer_load_dwordx4 v7, s[8:11], s31 offen lds
    s_add_u32 s30, s30, 128
    s_add_u32 s31, s31, 131072
    s_add_u32 s34, s34, 24576
    s_cmp_eq_u32 s34, 147456
    s_cselect_b32 s34, 0, s34
    s_add_u32 s36, s34, s35
    s_mov_b32 m0, s36
    s_nop 0
    buffer_load_dwordx4 v2, s[4:7], s30 offen lds
    s_add_u32 m0, s36, 1024
    s_nop 0
    buffer_load_dwordx4 v3, s[4:7], s30 offen lds
    s_add_u32 m0, s36, 2048
    s_nop 0
    buffer_load_dwordx4 v4, s[4:7], s30 offen lds
    s_add_u32 m0, s36, 3072
    s_nop 0
    buffer_load_dwordx4 v5, s[4:7], s30 offen lds
    s_add_u32 s36, s34, s44
    s_mov_b32 m0, s36
    s_nop 0
    buffer_load_dwordx4 v6, s[8:11], s31 offen lds
    s_add_u32 m0, s36, 1024
    s_nop 0
    buffer_load_dwordx4 v7, s[8:11], s31 offen lds
    s_add_u32 s30, s30, 128
    s_add_u32 s31, s31, 131072
    s_add_u32 s34, s34, 24576
    s_cmp_eq_u32 s34, 147456
    s_cselect_b32 s34, 0, s34
    s_add_u32 s36, s34, s35
    s_mov_b32 m0, s36
    s_nop 0
    buffer_load_dwordx4 v2, s[4:7], s30 offen lds
    s_add_u32 m0, s36, 1024
    s_nop 0
    buffer_load_dwordx4 v3, s[4:7], s30 offen lds
    s_add_u32 m0, s36, 2048
    s_nop 0
    buffer_load_dwordx4 v4, s[4:7], s30 offen lds
    s_add_u32 m0, s36, 3072
    s_nop 0
    buffer_load_dwordx4 v5, s[4:7], s30 offen lds
    s_add_u32 s36, s34, s44
    s_mov_b32 m0, s36
    s_nop 0
    buffer_load_dwordx4 v6, s[8:11], s31 offen lds
    s_add_u32 m0, s36, 1024
    s_nop 0
    buffer_load_dwordx4 v7, s[8:11], s31 offen lds
    s_add_u32 s30, s30, 128
    s_add_u32 s31, s31, 131072
    s_add_u32 s34, s34, 24576
    s_cmp_eq_u32 s34, 147456
    s_cselect_b32 s34, 0, s34
    s_add_u32 s36, s34, s35
    s_mov_b32 m0, s36
    s_nop 0
    buffer_load_dwordx4 v2, s[4:7], s30 offen lds
    s_add_u32 m0, s36, 1024
    s_nop 0
    buffer_load_dwordx4 v3, s[4:7], s30 offen lds
    s_add_u32 m0, s36, 2048
    s_nop 0
    buffer_load_dwordx4 v4, s[4:7], s30 offen lds
    s_add_u32 m0, s36, 3072
    s_nop 0
    buffer_load_dwordx4 v5, s[4:7], s30 offen lds
    s_add_u32 s36, s34, s44
    s_mov_b32 m0, s36
    s_nop 0
    buffer_load_dwordx4 v6, s[8:11], s31 offen lds
    s_add_u32 m0, s36, 1024
    s_nop 0
    buffer_load_dwordx4 v7, s[8:11], s31 offen lds
    s_add_u32 s30, s30, 128
    s_add_u32 s31, s31, 131072
    s_add_u32 s34, s34, 24576
    s_cmp_eq_u32 s34, 147456
    s_cselect_b32 s34, 0, s34
    s_add_u32 s36, s34, s35
    s_mov_b32 m0, s36
    s_nop 0
    buffer_load_dwordx4 v2, s[4:7], s30 offen lds
    s_add_u32 m0, s36, 1024
    s_nop 0
    buffer_load_dwordx4 v3, s[4:7], s30 offen lds
    s_add_u32 m0, s36, 2048
    s_nop 0
    buffer_load_dwordx4 v4, s[4:7], s30 offen lds
    s_add_u32 m0, s36, 3072
    s_nop 0
    buffer_load_dwordx4 v5, s[4:7], s30 offen lds
    s_add_u32 s36, s34, s44
    s_mov_b32 m0, s36
    s_nop 0
    buffer_load_dwordx4 v6, s[8:11], s31 offen lds
    s_add_u32 m0, s36, 1024
    s_nop 0
    buffer_load_dwordx4 v7, s[8:11], s31 offen lds
    s_add_u32 s30, s30, 128
    s_add_u32 s31, s31, 131072
    s_add_u32 s34, s34, 24576
    s_cmp_eq_u32 s34, 147456
    s_cselect_b32 s34, 0, s34
    s_waitcnt vmcnt(24)
    s_barrier
g2_kernel_lloop:
    s_waitcnt vmcnt(18)
    s_barrier
    s_add_u32 s36, s34, s35
    s_mov_b32 m0, s36
    s_nop 0
    buffer_load_dwordx4 v2, s[4:7], s30 offen lds
    s_add_u32 m0, s36, 1024
    s_nop 0
    buffer_load_dwordx4 v3, s[4:7], s30 offen lds
    s_add_u32 m0, s36, 2048
    s_nop 0
    buffer_load_dwordx4 v4, s[4:7], s30 offen lds
    s_add_u32 m0, s36, 3072
    s_nop 0
    buffer_load_dwordx4 v5, s[4:7], s30 offen lds
    s_add_u32 s36, s34, s44
    s_mov_b32 m0, s36
    s_nop 0
    buffer_load_dwordx4 v6, s[8:11], s31 offen lds
    s_add_u32 m0, s36, 1024
    s_nop 0
    buffer_load_dwordx4 v7, s[8:11], s31 offen lds
    s_add_u32 s30, s30, 128
    s_add_u32 s31, s31, 131072
    s_add_u32 s34, s34, 24576
    s_cmp_eq_u32 s34, 147456
    s_cselect_b32 s34, 0, s34
    s_add_u32 s37, s37, 1
    s_cmp_lt_u32 s37, 16
    s_cbranch_scc1 g2_kernel_lloop
    s_waitcnt vmcnt(0)
    s_endpgm
g2_kernel_comp:
    v_and_b32 v1, 15, v0
    v_lshlrev_b32 v1, 7, v1
    v_lshrrev_b32 v32, 4, v0
    v_and_b32 v33, 7, v0
    s_mul_i32 s25, s23, 8192
    v_add_u32 v1, s25, v1
    v_xor_b32 v34, v32, v33
    v_lshlrev_b32 v34, 4, v34
    v_add_u32 v8, v1, v34
    v_or_b32 v32, 4, v32
    v_xor_b32 v34, v32, v33
    v_lshlrev_b32 v34, 4, v34
    v_add_u32 v9, v1, v34
    v_lshrrev_b32 v1, 4, v0
    v_lshlrev_b32 v1, 3, v1
    v_bfe_u32 v32, v0, 2, 2
    v_add_u32 v1, v1, v32
    v_bfe_u32 v33, v0, 3, 1
    v_bfe_u32 v34, v0, 4, 1
    v_lshlrev_b32 v34, 1, v34
    v_or_b32 v33, v33, v34
    s_mul_i32 s25, s24, 2
    s_add_u32 s25, s25, 0
    v_xor_b32 v33, s25, v33
    v_lshlrev_b32 v33, 5, v33
    s_mov_b32 s26, 128
    v_mul_lo_u32 v1, v1, s26
    v_and_b32 v34, 3, v0
    v_lshlrev_b32 v34, 3, v34
    v_add3_u32 v10, v1, v33, v34
    v_lshrrev_b32 v1, 4, v0
    v_lshlrev_b32 v1, 3, v1
    v_bfe_u32 v32, v0, 2, 2
    v_add_u32 v1, v1, v32
    v_bfe_u32 v33, v0, 3, 1
    v_bfe_u32 v34, v0, 4, 1
    v_lshlrev_b32 v34, 1, v34
    v_or_b32 v33, v33, v34
    s_mul_i32 s25, s24, 2
    s_add_u32 s25, s25, 1
    v_xor_b32 v33, s25, v33
    v_lshlrev_b32 v33, 5, v33
    s_mov_b32 s26, 128
    v_mul_lo_u32 v1, v1, s26
    v_and_b32 v34, 3, v0
    v_lshlrev_b32 v34, 3, v34
    v_add3_u32 v11, v1, v33, v34
    v_mov_b32 v80, 0
    v_mov_b32 v81, 0
    v_mov_b32 v82, 0
    v_mov_b32 v83, 0
    v_mov_b32 v84, 0
    v_mov_b32 v85, 0
    v_mov_b32 v86, 0
    v_mov_b32 v87, 0
    v_mov_b32 v88, 0
    v_mov_b32 v89, 0
    v_mov_b32 v90, 0
    v_mov_b32 v91, 0
    v_mov_b32 v92, 0
    v_mov_b32 v93, 0
    v_mov_b32 v94, 0
    v_mov_b32 v95, 0
    v_mov_b32 v96, 0
    v_mov_b32 v97, 0
    v_mov_b32 v98, 0
    v_mov_b32 v99, 0
    v_mov_b32 v100, 0
    v_mov_b32 v101, 0
    v_mov_b32 v102, 0
    v_mov_b32 v103, 0
    v_mov_b32 v104, 0
    v_mov_b32 v105, 0
    v_mov_b32 v106, 0
    v_mov_b32 v107, 0
    v_mov_b32 v108, 0
    v_mov_b32 v109, 0
    v_mov_b32 v110, 0
    v_mov_b32 v111, 0
    s_mov_b32 s48, s64
    s_and_b32 s49, s65, 0xffff
    s_mov_b32 s50, 4194304
    s_mov_b32 s51, 0x00020000
    s_mul_i32 s25, s20, 128
    s_mul_i32 s26, s23, 64
    s_add_u32 s25, s25, s26
    v_and_b32 v32, 15, v0
    v_add_u32 v32, s25, v32
    s_mov_b32 s26, 2048
    v_mul_lo_u32 v32, v32, s26
    v_lshrrev_b32 v33, 4, v0
    v_lshlrev_b32 v33, 3, v33
    v_add_u32 v32, v32, v33
    s_mul_i32 s25, s21, 128
    s_mul_i32 s26, s24, 64
    s_add_u32 s25, s25, s26
    s_add_u32 s25, s25, 0
    v_add_u32 v34, s25, v32
    buffer_load_dwordx2 v[16:17], v34, s[48:51], 0 offen
    v_add_u32 v34, s25, v32
    v_add_u32 v34, 32768, v34
    buffer_load_dwordx2 v[20:21], v34, s[48:51], 0 offen
    v_add_u32 v34, s25, v32
    v_add_u32 v34, 65536, v34
    buffer_load_dwordx2 v[24:25], v34, s[48:51], 0 offen
    v_add_u32 v34, s25, v32
    v_add_u32 v34, 98304, v34
    buffer_load_dwordx2 v[28:29], v34, s[48:51], 0 offen
    s_mul_i32 s25, s21, 128
    s_mul_i32 s26, s24, 64
    s_add_u32 s25, s25, s26
    s_add_u32 s25, s25, 32
    v_add_u32 v34, s25, v32
    buffer_load_dwordx2 v[18:19], v34, s[48:51], 0 offen
    v_add_u32 v34, s25, v32
    v_add_u32 v34, 32768, v34
    buffer_load_dwordx2 v[22:23], v34, s[48:51], 0 offen
    v_add_u32 v34, s25, v32
    v_add_u32 v34, 65536, v34
    buffer_load_dwordx2 v[26:27], v34, s[48:51], 0 offen
    v_add_u32 v34, s25, v32
    v_add_u32 v34, 98304, v34
    buffer_load_dwordx2 v[30:31], v34, s[48:51], 0 offen
    s_mov_b32 s38, 0
    v_add_u32 v12, s38, v8
    v_add_u32 v13, s38, v9
    v_add_u32 v14, s38, v10
    v_add_u32 v15, s38, v11
    s_add_u32 s38, s38, 24576
    s_cmp_eq_u32 s38, 147456
    s_cselect_b32 s38, 0, s38
    s_barrier
    ds_read_b128 v[32:35], v12 offset:0
    ds_read_b128 v[36:39], v12 offset:2048
    ds_read_b128 v[40:43], v12 offset:4096
    ds_read_b128 v[44:47], v12 offset:6144
    ds_read_b64_tr_b16 v[64:65], v14 offset:16384
    ds_read_b64_tr_b16 v[66:67], v14 offset:16896
    ds_read_b64_tr_b16 v[68:69], v15 offset:16384
    ds_read_b64_tr_b16 v[70:71], v15 offset:16896
g2_kernel_loop:
    s_waitcnt lgkmcnt(0)
    v_mfma_f32_16x16x32_bf16 v[80:83], v[64:67], v[32:35], v[80:83]
    ds_read_b128 v[48:51], v13 offset:0
    v_mfma_f32_16x16x32_bf16 v[84:87], v[68:71], v[32:35], v[84:87]
    ds_read_b128 v[52:55], v13 offset:2048
    v_mfma_f32_16x16x32_bf16 v[88:91], v[64:67], v[36:39], v[88:91]
    ds_read_b128 v[56:59], v13 offset:4096
    v_mfma_f32_16x16x32_bf16 v[92:95], v[68:71], v[36:39], v[92:95]
    ds_read_b128 v[60:63], v13 offset:6144
    v_mfma_f32_16x16x32_bf16 v[96:99], v[64:67], v[40:43], v[96:99]
    ds_read_b64_tr_b16 v[72:73], v14 offset:20480
    v_mfma_f32_16x16x32_bf16 v[100:103], v[68:71], v[40:43], v[100:103]
    ds_read_b64_tr_b16 v[74:75], v14 offset:20992
    v_mfma_f32_16x16x32_bf16 v[104:107], v[64:67], v[44:47], v[104:107]
    ds_read_b64_tr_b16 v[76:77], v15 offset:20480
    v_mfma_f32_16x16x32_bf16 v[108:111], v[68:71], v[44:47], v[108:111]
    ds_read_b64_tr_b16 v[78:79], v15 offset:20992
    s_barrier
    s_waitcnt lgkmcnt(0)
    v_mfma_f32_16x16x32_bf16 v[80:83], v[72:75], v[48:51], v[80:83]
    v_add_u32 v12, s38, v8
    v_add_u32 v13, s38, v9
    v_mfma_f32_16x16x32_bf16 v[84:87], v[76:79], v[48:51], v[84:87]
    v_add_u32 v14, s38, v10
    v_add_u32 v15, s38, v11
    s_add_u32 s38, s38, 24576
    s_cmp_eq_u32 s38, 147456
    s_cselect_b32 s38, 0, s38
    v_mfma_f32_16x16x32_bf16 v[88:91], v[72:75], v[52:55], v[88:91]
    ds_read_b128 v[32:35], v12 offset:0
    ds_read_b128 v[36:39], v12 offset:2048
    v_mfma_f32_16x16x32_bf16 v[92:95], v[76:79], v[52:55], v[92:95]
    ds_read_b128 v[40:43], v12 offset:4096
    ds_read_b128 v[44:47], v12 offset:6144
    v_mfma_f32_16x16x32_bf16 v[96:99], v[72:75], v[56:59], v[96:99]
    ds_read_b64_tr_b16 v[64:65], v14 offset:16384
    ds_read_b64_tr_b16 v[66:67], v14 offset:16896
    v_mfma_f32_16x16x32_bf16 v[100:103], v[76:79], v[56:59], v[100:103]
    ds_read_b64_tr_b16 v[68:69], v15 offset:16384
    ds_read_b64_tr_b16 v[70:71], v15 offset:16896
    v_mfma_f32_16x16x32_bf16 v[104:107], v[72:75], v[60:63], v[104:107]
    v_mfma_f32_16x16x32_bf16 v[108:111], v[76:79], v[60:63], v[108:111]
    s_add_u32 s37, s37, 1
    s_cmp_lt_u32 s37, 16
    s_cbranch_scc1 g2_kernel_loop
g2_kernel_done:
    s_waitcnt vmcnt(0) lgkmcnt(0)
    s_nop 7
    s_add_u32 s40, s82, 20971520
    s_addc_u32 s41, s83, 0
    s_and_b32 s41, s41, 0xffff
    s_mov_b32 s42, 4194304
    s_mov_b32 s43, 0x00020000
    v_mov_b32 v32, 0
    v_mov_b32 v33, 0
    v_mov_b32 v34, 0
    v_mov_b32 v35, 0
    v_mov_b32 v36, 0
    v_mov_b32 v37, 0
    v_mov_b32 v38, 0
    v_mov_b32 v39, 0
    s_mul_i32 s25, s20, 128
    s_mul_i32 s26, s23, 64
    s_add_u32 s25, s25, s26
    v_and_b32 v1, 15, v0
    v_add_u32 v1, s25, v1
    s_mov_b32 s26, 2048
    v_mul_lo_u32 v1, v1, s26
    v_lshrrev_b32 v2, 4, v0
    v_lshlrev_b32 v2, 3, v2
    v_add_u32 v1, v1, v2
    s_mul_i32 s25, s21, 128
    s_mul_i32 s26, s24, 64
    s_add_u32 s25, s25, s26
    s_add_u32 s25, s25, 0
    v_add_u32 v3, s25, v1
    v_cvt_pk_bf16_f32 v80, v80, v81
    v_cvt_pk_bf16_f32 v81, v82, v83
    v_lshlrev_b32 v6, 16, v80
    v_and_b32 v7, 0xffff0000, v80
    v_lshlrev_b32 v8, 16, v16
    v_and_b32 v9, 0xffff0000, v16
    v_add_f32 v6, v6, v8
    v_add_f32 v7, v7, v9
    v_cvt_pk_bf16_f32 v80, v6, v7
    v_lshlrev_b32 v6, 16, v80
    v_and_b32 v7, 0xffff0000, v80
    v_add_f32 v32, v32, v6
    v_fmac_f32 v33, v6, v6
    v_add_f32 v32, v32, v7
    v_fmac_f32 v33, v7, v7
    v_lshlrev_b32 v6, 16, v81
    v_and_b32 v7, 0xffff0000, v81
    v_lshlrev_b32 v8, 16, v17
    v_and_b32 v9, 0xffff0000, v17
    v_add_f32 v6, v6, v8
    v_add_f32 v7, v7, v9
    v_cvt_pk_bf16_f32 v81, v6, v7
    v_lshlrev_b32 v6, 16, v81
    v_and_b32 v7, 0xffff0000, v81
    v_add_f32 v32, v32, v6
    v_fmac_f32 v33, v6, v6
    v_add_f32 v32, v32, v7
    v_fmac_f32 v33, v7, v7
    v_add_u32 v4, 0, v3
    buffer_store_dwordx2 v[80:81], v4, s[40:43], 0 offen
    v_cvt_pk_bf16_f32 v88, v88, v89
    v_cvt_pk_bf16_f32 v89, v90, v91
    v_lshlrev_b32 v6, 16, v88
    v_and_b32 v7, 0xffff0000, v88
    v_lshlrev_b32 v8, 16, v20
    v_and_b32 v9, 0xffff0000, v20
    v_add_f32 v6, v6, v8
    v_add_f32 v7, v7, v9
    v_cvt_pk_bf16_f32 v88, v6, v7
    v_lshlrev_b32 v6, 16, v88
    v_and_b32 v7, 0xffff0000, v88
    v_add_f32 v34, v34, v6
    v_fmac_f32 v35, v6, v6
    v_add_f32 v34, v34, v7
    v_fmac_f32 v35, v7, v7
    v_lshlrev_b32 v6, 16, v89
    v_and_b32 v7, 0xffff0000, v89
    v_lshlrev_b32 v8, 16, v21
    v_and_b32 v9, 0xffff0000, v21
    v_add_f32 v6, v6, v8
    v_add_f32 v7, v7, v9
    v_cvt_pk_bf16_f32 v89, v6, v7
    v_lshlrev_b32 v6, 16, v89
    v_and_b32 v7, 0xffff0000, v89
    v_add_f32 v34, v34, v6
    v_fmac_f32 v35, v6, v6
    v_add_f32 v34, v34, v7
    v_fmac_f32 v35, v7, v7
    v_add_u32 v4, 32768, v3
    buffer_store_dwordx2 v[88:89], v4, s[40:43], 0 offen
    v_cvt_pk_bf16_f32 v96, v96, v97
    v_cvt_pk_bf16_f32 v97, v98, v99
    v_lshlrev_b32 v6, 16, v96
    v_and_b32 v7, 0xffff0000, v96
    v_lshlrev_b32 v8, 16, v24
    v_and_b32 v9, 0xffff0000, v24
    v_add_f32 v6, v6, v8
    v_add_f32 v7, v7, v9
    v_cvt_pk_bf16_f32 v96, v6, v7
    v_lshlrev_b32 v6, 16, v96
    v_and_b32 v7, 0xffff0000, v96
    v_add_f32 v36, v36, v6
    v_fmac_f32 v37, v6, v6
    v_add_f32 v36, v36, v7
    v_fmac_f32 v37, v7, v7
    v_lshlrev_b32 v6, 16, v97
    v_and_b32 v7, 0xffff0000, v97
    v_lshlrev_b32 v8, 16, v25
    v_and_b32 v9, 0xffff0000, v25
    v_add_f32 v6, v6, v8
    v_add_f32 v7, v7, v9
    v_cvt_pk_bf16_f32 v97, v6, v7
    v_lshlrev_b32 v6, 16, v97
    v_and_b32 v7, 0xffff0000, v97
    v_add_f32 v36, v36, v6
    v_fmac_f32 v37, v6, v6
    v_add_f32 v36, v36, v7
    v_fmac_f32 v37, v7, v7
    v_add_u32 v4, 65536, v3
    buffer_store_dwordx2 v[96:97], v4, s[40:43], 0 offen
    v_cvt_pk_bf16_f32 v104, v104, v105
    v_cvt_pk_bf16_f32 v105, v106, v107
    v_lshlrev_b32 v6, 16, v104
    v_and_b32 v7, 0xffff0000, v104
    v_lshlrev_b32 v8, 16, v28
    v_and_b32 v9, 0xffff0000, v28
    v_add_f32 v6, v6, v8
    v_add_f32 v7, v7, v9
    v_cvt_pk_bf16_f32 v104, v6, v7
    v_lshlrev_b32 v6, 16, v104
    v_and_b32 v7, 0xffff0000, v104
    v_add_f32 v38, v38, v6
    v_fmac_f32 v39, v6, v6
    v_add_f32 v38, v38, v7
    v_fmac_f32 v39, v7, v7
    v_lshlrev_b32 v6, 16, v105
    v_and_b32 v7, 0xffff0000, v105
    v_lshlrev_b32 v8, 16, v29
    v_and_b32 v9, 0xffff0000, v29
    v_add_f32 v6, v6, v8
    v_add_f32 v7, v7, v9
    v_cvt_pk_bf16_f32 v105, v6, v7
    v_lshlrev_b32 v6, 16, v105
    v_and_b32 v7, 0xffff0000, v105
    v_add_f32 v38, v38, v6
    v_fmac_f32 v39, v6, v6
    v_add_f32 v38, v38, v7
    v_fmac_f32 v39, v7, v7
    v_add_u32 v4, 98304, v3
    buffer_store_dwordx2 v[104:105], v4, s[40:43], 0 offen
    s_mul_i32 s25, s21, 128
    s_mul_i32 s26, s24, 64
    s_add_u32 s25, s25, s26
    s_add_u32 s25, s25, 32
    v_add_u32 v3, s25, v1
    v_cvt_pk_bf16_f32 v84, v84, v85
    v_cvt_pk_bf16_f32 v85, v86, v87
    v_lshlrev_b32 v6, 16, v84
    v_and_b32 v7, 0xffff0000, v84
    v_lshlrev_b32 v8, 16, v18
    v_and_b32 v9, 0xffff0000, v18
    v_add_f32 v6, v6, v8
    v_add_f32 v7, v7, v9
    v_cvt_pk_bf16_f32 v84, v6, v7
    v_lshlrev_b32 v6, 16, v84
    v_and_b32 v7, 0xffff0000, v84
    v_add_f32 v32, v32, v6
    v_fmac_f32 v33, v6, v6
    v_add_f32 v32, v32, v7
    v_fmac_f32 v33, v7, v7
    v_lshlrev_b32 v6, 16, v85
    v_and_b32 v7, 0xffff0000, v85
    v_lshlrev_b32 v8, 16, v19
    v_and_b32 v9, 0xffff0000, v19
    v_add_f32 v6, v6, v8
    v_add_f32 v7, v7, v9
    v_cvt_pk_bf16_f32 v85, v6, v7
    v_lshlrev_b32 v6, 16, v85
    v_and_b32 v7, 0xffff0000, v85
    v_add_f32 v32, v32, v6
    v_fmac_f32 v33, v6, v6
    v_add_f32 v32, v32, v7
    v_fmac_f32 v33, v7, v7
    v_add_u32 v4, 0, v3
    buffer_store_dwordx2 v[84:85], v4, s[40:43], 0 offen
    v_cvt_pk_bf16_f32 v92, v92, v93
    v_cvt_pk_bf16_f32 v93, v94, v95
    v_lshlrev_b32 v6, 16, v92
    v_and_b32 v7, 0xffff0000, v92
    v_lshlrev_b32 v8, 16, v22
    v_and_b32 v9, 0xffff0000, v22
    v_add_f32 v6, v6, v8
    v_add_f32 v7, v7, v9
    v_cvt_pk_bf16_f32 v92, v6, v7
    v_lshlrev_b32 v6, 16, v92
    v_and_b32 v7, 0xffff0000, v92
    v_add_f32 v34, v34, v6
    v_fmac_f32 v35, v6, v6
    v_add_f32 v34, v34, v7
    v_fmac_f32 v35, v7, v7
    v_lshlrev_b32 v6, 16, v93
    v_and_b32 v7, 0xffff0000, v93
    v_lshlrev_b32 v8, 16, v23
    v_and_b32 v9, 0xffff0000, v23
    v_add_f32 v6, v6, v8
    v_add_f32 v7, v7, v9
    v_cvt_pk_bf16_f32 v93, v6, v7
    v_lshlrev_b32 v6, 16, v93
    v_and_b32 v7, 0xffff0000, v93
    v_add_f32 v34, v34, v6
    v_fmac_f32 v35, v6, v6
    v_add_f32 v34, v34, v7
    v_fmac_f32 v35, v7, v7
    v_add_u32 v4, 32768, v3
    buffer_store_dwordx2 v[92:93], v4, s[40:43], 0 offen
    v_cvt_pk_bf16_f32 v100, v100, v101
    v_cvt_pk_bf16_f32 v101, v102, v103
    v_lshlrev_b32 v6, 16, v100
    v_and_b32 v7, 0xffff0000, v100
    v_lshlrev_b32 v8, 16, v26
    v_and_b32 v9, 0xffff0000, v26
    v_add_f32 v6, v6, v8
    v_add_f32 v7, v7, v9
    v_cvt_pk_bf16_f32 v100, v6, v7
    v_lshlrev_b32 v6, 16, v100
    v_and_b32 v7, 0xffff0000, v100
    v_add_f32 v36, v36, v6
    v_fmac_f32 v37, v6, v6
    v_add_f32 v36, v36, v7
    v_fmac_f32 v37, v7, v7
    v_lshlrev_b32 v6, 16, v101
    v_and_b32 v7, 0xffff0000, v101
    v_lshlrev_b32 v8, 16, v27
    v_and_b32 v9, 0xffff0000, v27
    v_add_f32 v6, v6, v8
    v_add_f32 v7, v7, v9
    v_cvt_pk_bf16_f32 v101, v6, v7
    v_lshlrev_b32 v6, 16, v101
    v_and_b32 v7, 0xffff0000, v101
    v_add_f32 v36, v36, v6
    v_fmac_f32 v37, v6, v6
    v_add_f32 v36, v36, v7
    v_fmac_f32 v37, v7, v7
    v_add_u32 v4, 65536, v3
    buffer_store_dwordx2 v[100:101], v4, s[40:43], 0 offen
    v_cvt_pk_bf16_f32 v108, v108, v109
    v_cvt_pk_bf16_f32 v109, v110, v111
    v_lshlrev_b32 v6, 16, v108
    v_and_b32 v7, 0xffff0000, v108
    v_lshlrev_b32 v8, 16, v30
    v_and_b32 v9, 0xffff0000, v30
    v_add_f32 v6, v6, v8
    v_add_f32 v7, v7, v9
    v_cvt_pk_bf16_f32 v108, v6, v7
    v_lshlrev_b32 v6, 16, v108
    v_and_b32 v7, 0xffff0000, v108
    v_add_f32 v38, v38, v6
    v_fmac_f32 v39, v6, v6
    v_add_f32 v38, v38, v7
    v_fmac_f32 v39, v7, v7
    v_lshlrev_b32 v6, 16, v109
    v_and_b32 v7, 0xffff0000, v109
    v_lshlrev_b32 v8, 16, v31
    v_and_b32 v9, 0xffff0000, v31
    v_add_f32 v6, v6, v8
    v_add_f32 v7, v7, v9
    v_cvt_pk_bf16_f32 v109, v6, v7
    v_lshlrev_b32 v6, 16, v109
    v_and_b32 v7, 0xffff0000, v109
    v_add_f32 v38, v38, v6
    v_fmac_f32 v39, v6, v6
    v_add_f32 v38, v38, v7
    v_fmac_f32 v39, v7, v7
    v_add_u32 v4, 98304, v3
    buffer_store_dwordx2 v[108:109], v4, s[40:43], 0 offen
    s_add_u32 s44, s82, 51380224
    s_addc_u32 s45, s83, 0
    s_and_b32 s45, s45, 0xffff
    s_mov_b32 s46, 524288
    s_mov_b32 s47, 0x00020000
    ds_swizzle_b32 v2, v32 offset:0x401F
    s_waitcnt lgkmcnt(0)
    v_add_f32 v32, v32, v2
    v_mov_b32 v2, v32
    s_nop 1
    v_permlane32_swap_b32 v32, v2
    v_add_f32 v32, v32, v2
    ds_swizzle_b32 v2, v33 offset:0x401F
    s_waitcnt lgkmcnt(0)
    v_add_f32 v33, v33, v2
    v_mov_b32 v2, v33
    s_nop 1
    v_permlane32_swap_b32 v33, v2
    v_add_f32 v33, v33, v2
    ds_swizzle_b32 v2, v34 offset:0x401F
    s_waitcnt lgkmcnt(0)
    v_add_f32 v34, v34, v2
    v_mov_b32 v2, v34
    s_nop 1
    v_permlane32_swap_b32 v34, v2
    v_add_f32 v34, v34, v2
    ds_swizzle_b32 v2, v35 offset:0x401F
    s_waitcnt lgkmcnt(0)
    v_add_f32 v35, v35, v2
    v_mov_b32 v2, v35
    s_nop 1
    v_permlane32_swap_b32 v35, v2
    v_add_f32 v35, v35, v2
    ds_swizzle_b32 v2, v36 offset:0x401F
    s_waitcnt lgkmcnt(0)
    v_add_f32 v36, v36, v2
    v_mov_b32 v2, v36
    s_nop 1
    v_permlane32_swap_b32 v36, v2
    v_add_f32 v36, v36, v2
    ds_swizzle_b32 v2, v37 offset:0x401F
    s_waitcnt lgkmcnt(0)
    v_add_f32 v37, v37, v2
    v_mov_b32 v2, v37
    s_nop 1
    v_permlane32_swap_b32 v37, v2
    v_add_f32 v37, v37, v2
    ds_swizzle_b32 v2, v38 offset:0x401F
    s_waitcnt lgkmcnt(0)
    v_add_f32 v38, v38, v2
    v_mov_b32 v2, v38
    s_nop 1
    v_permlane32_swap_b32 v38, v2
    v_add_f32 v38, v38, v2
    ds_swizzle_b32 v2, v39 offset:0x401F
    s_waitcnt lgkmcnt(0)
    v_add_f32 v39, v39, v2
    v_mov_b32 v2, v39
    s_nop 1
    v_permlane32_swap_b32 v39, v2
    v_add_f32 v39, v39, v2
    s_mul_i32 s25, s20, 128
    s_mul_i32 s26, s23, 64
    s_add_u32 s25, s25, s26
    v_add_u32 v1, s25, v0
    v_lshlrev_b32 v1, 4, v1
    s_lshl_b32 s25, s21, 15
    s_lshl_b32 s26, s24, 3
    s_add_u32 s25, s25, s26
    v_add_u32 v1, s25, v1
    v_cmp_gt_u32 vcc, 16, v0
    s_and_saveexec_b64 s[52:53], vcc
    v_add_u32 v2, 0, v1
    buffer_store_dwordx2 v[32:33], v2, s[44:47], 0 offen
    v_add_u32 v2, 256, v1
    buffer_store_dwordx2 v[34:35], v2, s[44:47], 0 offen
    v_add_u32 v2, 512, v1
    buffer_store_dwordx2 v[36:37], v2, s[44:47], 0 offen
    v_add_u32 v2, 768, v1
    buffer_store_dwordx2 v[38:39], v2, s[44:47], 0 offen
    s_mov_b64 exec, s[52:53]
g2_kernel_end:
    s_endpgm
.globl g3_kernel
.p2align 8
.type g3_kernel,@function
g3_kernel:
    s_cmp_ge_u32 s2, 256
    s_cbranch_scc1 g3_kernel_end
    s_load_dwordx16 s[64:79], s[0:1], 0
    s_load_dwordx4 s[80:83], s[0:1], 64
    s_waitcnt lgkmcnt(0)
    s_cmp_lt_u32 s2, 224
    s_cbranch_scc1 g3_kernel_main
    s_mov_b32 s4, s76
    s_and_b32 s5, s77, 0xffff
    s_mov_b32 s6, 7340032
    s_mov_b32 s7, 0x00020000
    s_sub_u32 s20, s2, 224
    s_mul_i32 s20, s20, 229376
    v_lshlrev_b32 v1, 4, v0
    v_add_u32 v1, s20, v1
    buffer_load_dwordx4 v[8:11], v1, s[4:7], 0 offen
    v_add_u32 v1, 8192, v1
    buffer_load_dwordx4 v[12:15], v1, s[4:7], 0 offen
    v_add_u32 v1, 8192, v1
    buffer_load_dwordx4 v[16:19], v1, s[4:7], 0 offen
    v_add_u32 v1, 8192, v1
    buffer_load_dwordx4 v[20:23], v1, s[4:7], 0 offen
    v_add_u32 v1, 8192, v1
    buffer_load_dwordx4 v[24:27], v1, s[4:7], 0 offen
    v_add_u32 v1, 8192, v1
    buffer_load_dwordx4 v[28:31], v1, s[4:7], 0 offen
    v_add_u32 v1, 8192, v1
    buffer_load_dwordx4 v[32:35], v1, s[4:7], 0 offen
    v_add_u32 v1, 8192, v1
    buffer_load_dwordx4 v[36:39], v1, s[4:7], 0 offen
    v_add_u32 v1, 8192, v1
    buffer_load_dwordx4 v[40:43], v1, s[4:7], 0 offen
    v_add_u32 v1, 8192, v1
    buffer_load_dwordx4 v[44:47], v1, s[4:7], 0 offen
    v_add_u32 v1, 8192, v1
    buffer_load_dwordx4 v[48:51], v1, s[4:7], 0 offen
    v_add_u32 v1, 8192, v1
    buffer_load_dwordx4 v[52:55], v1, s[4:7], 0 offen
    v_add_u32 v1, 8192, v1
    buffer_load_dwordx4 v[56:59], v1, s[4:7], 0 offen
    v_add_u32 v1, 8192, v1
    buffer_load_dwordx4 v[60:63], v1, s[4:7], 0 offen
    v_add_u32 v1, 8192, v1
    buffer_load_dwordx4 v[64:67], v1, s[4:7], 0 offen
    v_add_u32 v1, 8192, v1
    buffer_load_dwordx4 v[68:71], v1, s[4:7], 0 offen
    v_add_u32 v1, 8192, v1
    buffer_load_dwordx4 v[72:75], v1, s[4:7], 0 offen
    v_add_u32 v1, 8192, v1
    buffer_load_dwordx4 v[76:79], v1, s[4:7], 0 offen
    v_add_u32 v1, 8192, v1
    buffer_load_dwordx4 v[80:83], v1, s[4:7], 0 offen
    v_add_u32 v1, 8192, v1
    buffer_load_dwordx4 v[84:87], v1, s[4:7], 0 offen
    v_add_u32 v1, 8192, v1
    buffer_load_dwordx4 v[88:91], v1, s[4:7], 0 offen
    v_add_u32 v1, 8192, v1
    buffer_load_dwordx4 v[92:95], v1, s[4:7], 0 offen
    v_add_u32 v1, 8192, v1
    buffer_load_dwordx4 v[96:99], v1, s[4:7], 0 offen
    v_add_u32 v1, 8192, v1
    buffer_load_dwordx4 v[100:103], v1, s[4:7], 0 offen
    v_add_u32 v1, 8192, v1
    buffer_load_dwordx4 v[104:107], v1, s[4:7], 0 offen
    v_add_u32 v1, 8192, v1
    buffer_load_dwordx4 v[108:111], v1, s[4:7], 0 offen
    v_add_u32 v1, 8192, v1
    buffer_load_dwordx4 v[112:115], v1, s[4:7], 0 offen
    v_add_u32 v1, 8192, v1
    buffer_load_dwordx4 v[116:119], v1, s[4:7], 0 offen
    v_add_u32 v1, 8192, v1
    s_waitcnt vmcnt(0)
    s_endpgm
g3_kernel_main:
    s_add_u32 s4, s82, 20971520
    s_addc_u32 s5, s83, 0
    s_and_b32 s5, s5, 0xffff
    s_mov_b32 s6, 4194304
    s_mov_b32 s7, 0x00020000
    s_mov_b32 s8, s72
    s_and_b32 s9, s73, 0xffff
    s_mov_b32 s10, 7340032
    s_mov_b32 s11, 0x00020000
    s_mov_b32 s12, s74
    s_and_b32 s13, s75, 0xffff
    s_mov_b32 s14, 7340032
    s_mov_b32 s15, 0x00020000
    s_and_b32 s25, s2, 7
    s_lshr_b32 s26, s2, 3
    s_and_b32 s20, s25, 1
    s_mul_i32 s20, s20, 4
    s_and_b32 s27, s26, 3
    s_add_u32 s20, s20, s27
    s_lshr_b32 s21, s25, 1
    s_mul_i32 s21, s21, 7
    s_lshr_b32 s27, s26, 2
    s_add_u32 s21, s21, s27
    v_lshrrev_b32 v1, 6, v0
    s_nop 0
    v_readfirstlane_b32 s19, v1
    s_and_b32 s23, s19, 3
    s_lshr_b32 s24, s19, 2
    s_and_b32 s24, s24, 1
    s_mov_b32 s22, s19
    v_and_b32 v0, 63, v0
    v_lshrrev_b32 v1, 3, v0
    v_and_b32 v32, 7, v0
    v_xor_b32 v32, v32, v1
    v_lshlrev_b32 v32, 4, v32
    s_mul_i32 s25, s22, 32
    s_mul_i32 s26, s20, 256
    s_add_u32 s25, s25, s26
    v_add_u32 v1, s25, v1
    s_mov_b32 s26, 2048
    v_mul_lo_u32 v1, v1, s26
    v_add_u32 v2, v1, v32
    v_add_u32 v3, 16384, v2
    v_add_u32 v4, 32768, v2
    v_add_u32 v5, 49152, v2
    s_mul_i32 s25, s22, 8
    s_add_u32 s25, s25, 0
    v_lshrrev_b32 v1, 4, v0
    v_add_u32 v1, s25, v1
    v_and_b32 v32, 3, v1
    v_lshrrev_b32 v33, 1, v1
    v_and_b32 v33, 4, v33
    v_or_b32 v32, v32, v33
    v_lshlrev_b32 v32, 1, v32
    v_and_b32 v33, 15, v0
    v_xor_b32 v32, v32, v33
    v_lshlrev_b32 v32, 4, v32
    s_mov_b32 s26, 7168
    v_mul_lo_u32 v1, v1, s26
    v_add_u32 v1, v1, v32
    s_mul_i32 s26, s21, 256
    v_add_u32 v6, s26, v1
    s_mul_i32 s25, s22, 8
    s_add_u32 s25, s25, 4
    v_lshrrev_b32 v1, 4, v0
    v_add_u32 v1, s25, v1
    v_and_b32 v32, 3, v1
    v_lshrrev_b32 v33, 1, v1
    v_and_b32 v33, 4, v33
    v_or_b32 v32, v32, v33
    v_lshlrev_b32 v32, 1, v32
    v_and_b32 v33, 15, v0
    v_xor_b32 v32, v32, v33
    v_lshlrev_b32 v32, 4, v32
    s_mov_b32 s26, 7168
    v_mul_lo_u32 v1, v1, s26
    v_add_u32 v1, v1, v32
    s_mul_i32 s26, s21, 256
    v_add_u32 v7, s26, v1
    s_mul_i32 s25, s22, 8
    s_add_u32 s25, s25, 0
    v_lshrrev_b32 v1, 4, v0
    v_add_u32 v1, s25, v1
    v_and_b32 v32, 3, v1
    v_lshrrev_b32 v33, 1, v1
    v_and_b32 v33, 4, v33
    v_or_b32 v32, v32, v33
    v_lshlrev_b32 v32, 1, v32
    v_and_b32 v33, 15, v0
    v_xor_b32 v32, v32, v33
    v_lshlrev_b32 v32, 4, v32
    s_mov_b32 s26, 7168
    v_mul_lo_u32 v1, v1, s26
    v_add_u32 v1, v1, v32
    s_mul_i32 s26, s21, 256
    v_add_u32 v8, s26, v1
    s_mul_i32 s25, s22, 8
    s_add_u32 s25, s25, 4
    v_lshrrev_b32 v1, 4, v0
    v_add_u32 v1, s25, v1
    v_and_b32 v32, 3, v1
    v_lshrrev_b32 v33, 1, v1
    v_and_b32 v33, 4, v33
    v_or_b32 v32, v32, v33
    v_lshlrev_b32 v32, 1, v32
    v_and_b32 v33, 15, v0
    v_xor_b32 v32, v32, v33
    v_lshlrev_b32 v32, 4, v32
    s_mov_b32 s26, 7168
    v_mul_lo_u32 v1, v1, s26
    v_add_u32 v1, v1, v32
    s_mul_i32 s26, s21, 256
    v_add_u32 v9, s26, v1
    s_mov_b32 s30, 0
    s_mov_b32 s31, 0
    s_mov_b32 s32, 0
    s_mov_b32 s34, 0
    s_mul_i32 s35, s22, 4096
    s_mul_i32 s44, s22, 2048
    s_add_u32 s44, s44, 32768
    s_mul_i32 s45, s22, 2048
    s_add_u32 s45, s45, 49152
    s_mov_b32 s37, 0
    s_add_u32 s36, s34, s35
    s_mov_b32 m0, s36
    s_nop 0
    buffer_load_dwordx4 v2, s[4:7], s30 offen lds
    s_add_u32 m0, s36, 1024
    s_nop 0
    buffer_load_dwordx4 v3, s[4:7], s30 offen lds
    s_add_u32 m0, s36, 2048
    s_nop 0
    buffer_load_dwordx4 v4, s[4:7], s30 offen lds
    s_add_u32 m0, s36, 3072
    s_nop 0
    buffer_load_dwordx4 v5, s[4:7], s30 offen lds
    s_add_u32 s36, s34, s44
    s_mov_b32 m0, s36
    s_nop 0
    buffer_load_dwordx4 v6, s[8:11], s31 offen lds
    s_add_u32 m0, s36, 1024
    s_nop 0
    buffer_load_dwordx4 v7, s[8:11], s31 offen lds
    s_add_u32 s36, s34, s45
    s_mov_b32 m0, s36
    s_nop 0
    buffer_load_dwordx4 v8, s[12:15], s32 offen lds
    s_add_u32 m0, s36, 1024
    s_nop 0
    buffer_load_dwordx4 v9, s[12:15], s32 offen lds
    s_add_u32 s30, s30, 128
    s_add_u32 s31, s31, 458752
    s_add_u32 s32, s32, 458752
    s_add_u32 s34, s34, 65536
    s_cmp_eq_u32 s34, 131072
    s_cselect_b32 s34, 0, s34
    v_and_b32 v1, 15, v0
    v_lshlrev_b32 v1, 7, v1
    v_lshrrev_b32 v32, 4, v0
    v_and_b32 v33, 7, v0
    s_mul_i32 s25, s23, 8192
    v_add_u32 v1, s25, v1
    v_xor_b32 v34, v32, v33
    v_lshlrev_b32 v34, 4, v34
    v_add_u32 v10, v1, v34
    v_or_b32 v32, 4, v32
    v_xor_b32 v34, v32, v33
    v_lshlrev_b32 v34, 4, v34
    v_add_u32 v11, v1, v34
    v_lshrrev_b32 v1, 4, v0
    v_lshlrev_b32 v1, 3, v1
    v_bfe_u32 v32, v0, 2, 2
    v_add_u32 v1, v1, v32
    v_bfe_u32 v33, v0, 4, 1
    v_lshlrev_b32 v33, 2, v33
    v_or_b32 v33, v33, v32
    s_mul_i32 s25, s24, 4
    s_add_u32 s25, s25, 0
    v_xor_b32 v33, s25, v33
    v_lshlrev_b32 v33, 5, v33
    s_mov_b32 s26, 256
    v_mul_lo_u32 v1, v1, s26
    v_and_b32 v34, 3, v0
    v_lshlrev_b32 v34, 3, v34
    v_add3_u32 v12, v1, v33, v34
    v_lshrrev_b32 v1, 4, v0
    v_lshlrev_b32 v1, 3, v1
    v_bfe_u32 v32, v0, 2, 2
    v_add_u32 v1, v1, v32
    v_bfe_u32 v33, v0, 4, 1
    v_lshlrev_b32 v33, 2, v33
    v_or_b32 v33, v33, v32
    s_mul_i32 s25, s24, 4
    s_add_u32 s25, s25, 1
    v_xor_b32 v33, s25, v33
    v_lshlrev_b32 v33, 5, v33
    s_mov_b32 s26, 256
    v_mul_lo_u32 v1, v1, s26
    v_and_b32 v34, 3, v0
    v_lshlrev_b32 v34, 3, v34
    v_add3_u32 v13, v1, v33, v34
    v_lshrrev_b32 v1, 4, v0
    v_lshlrev_b32 v1, 3, v1
    v_bfe_u32 v32, v0, 2, 2
    v_add_u32 v1, v1, v32
    v_bfe_u32 v33, v0, 4, 1
    v_lshlrev_b32 v33, 2, v33
    v_or_b32 v33, v33, v32
    s_mul_i32 s25, s24, 4
    s_add_u32 s25, s25, 2
    v_xor_b32 v33, s25, v33
    v_lshlrev_b32 v33, 5, v33
    s_mov_b32 s26, 256
    v_mul_lo_u32 v1, v1, s26
    v_and_b32 v34, 3, v0
    v_lshlrev_b32 v34, 3, v34
    v_add3_u32 v14, v1, v33, v34
    v_lshrrev_b32 v1, 4, v0
    v_lshlrev_b32 v1, 3, v1
    v_bfe_u32 v32, v0, 2, 2
    v_add_u32 v1, v1, v32
    v_bfe_u32 v33, v0, 4, 1
    v_lshlrev_b32 v33, 2, v33
    v_or_b32 v33, v33, v32
    s_mul_i32 s25, s24, 4
    s_add_u32 s25, s25, 3
    v_xor_b32 v33, s25, v33
    v_lshlrev_b32 v33, 5, v33
    s_mov_b32 s26, 256
    v_mul_lo_u32 v1, v1, s26
    v_and_b32 v34, 3, v0
    v_lshlrev_b32 v34, 3, v34
    v_add3_u32 v15, v1, v33, v34
    v_lshrrev_b32 v1, 4, v0
    v_lshlrev_b32 v1, 3, v1
    v_bfe_u32 v32, v0, 2, 2
    v_add_u32 v1, v1, v32
    v_bfe_u32 v33, v0, 4, 1
    v_lshlrev_b32 v33, 2, v33
    v_or_b32 v33, v33, v32
    s_mul_i32 s25, s24, 4
    s_add_u32 s25, s25, 0
    v_xor_b32 v33, s25, v33
    v_lshlrev_b32 v33, 5, v33
    s_mov_b32 s26, 256
    v_mul_lo_u32 v1, v1, s26
    v_and_b32 v34, 3, v0
    v_lshlrev_b32 v34, 3, v34
    v_add3_u32 v16, v1, v33, v34
    v_lshrrev_b32 v1, 4, v0
    v_lshlrev_b32 v1, 3, v1
    v_bfe_u32 v32, v0, 2, 2
    v_add_u32 v1, v1, v32
    v_bfe_u32 v33, v0, 4, 1
    v_lshlrev_b32 v33, 2, v33
    v_or_b32 v33, v33, v32
    s_mul_i32 s25, s24, 4
    s_add_u32 s25, s25, 1
    v_xor_b32 v33, s25, v33
    v_lshlrev_b32 v33, 5, v33
    s_mov_b32 s26, 256
    v_mul_lo_u32 v1, v1, s26
    v_and_b32 v34, 3, v0
    v_lshlrev_b32 v34, 3, v34
    v_add3_u32 v17, v1, v33, v34
    v_lshrrev_b32 v1, 4, v0
    v_lshlrev_b32 v1, 3, v1
    v_bfe_u32 v32, v0, 2, 2
    v_add_u32 v1, v1, v32
    v_bfe_u32 v33, v0, 4, 1
    v_lshlrev_b32 v33, 2, v33
    v_or_b32 v33, v33, v32
    s_mul_i32 s25, s24, 4
    s_add_u32 s25, s25, 2
    v_xor_b32 v33, s25, v33
    v_lshlrev_b32 v33, 5, v33
    s_mov_b32 s26, 256
    v_mul_lo_u32 v1, v1, s26
    v_and_b32 v34, 3, v0
    v_lshlrev_b32 v34, 3, v34
    v_add3_u32 v18, v1, v33, v34
    v_lshrrev_b32 v1, 4, v0
    v_lshlrev_b32 v1, 3, v1
    v_bfe_u32 v32, v0, 2, 2
    v_add_u32 v1, v1, v32
    v_bfe_u32 v33, v0, 4, 1
    v_lshlrev_b32 v33, 2, v33
    v_or_b32 v33, v33, v32
    s_mul_i32 s25, s24, 4
    s_add_u32 s25, s25, 3
    v_xor_b32 v33, s25, v33
    v_lshlrev_b32 v33, 5, v33
    s_mov_b32 s26, 256
    v_mul_lo_u32 v1, v1, s26
    v_and_b32 v34, 3, v0
    v_lshlrev_b32 v34, 3, v34
    v_add3_u32 v19, v1, v33, v34
    v_mov_b32 v28, 0x3f803f80
    v_mov_b32 v128, 0
    v_mov_b32 v129, 0
    v_mov_b32 v130, 0
    v_mov_b32 v131, 0
    v_mov_b32 v132, 0
    v_mov_b32 v133, 0
    v_mov_b32 v134, 0
    v_mov_b32 v135, 0
    v_mov_b32 v136, 0
    v_mov_b32 v137, 0
    v_mov_b32 v138, 0
    v_mov_b32 v139, 0
    v_mov_b32 v140, 0
    v_mov_b32 v141, 0
    v_mov_b32 v142, 0
    v_mov_b32 v143, 0
    v_mov_b32 v144, 0
    v_mov_b32 v145, 0
    v_mov_b32 v146, 0
    v_mov_b32 v147, 0
    v_mov_b32 v148, 0
    v_mov_b32 v149, 0
    v_mov_b32 v150, 0
    v_mov_b32 v151, 0
    v_mov_b32 v152, 0
    v_mov_b32 v153, 0
    v_mov_b32 v154, 0
    v_mov_b32 v155, 0
    v_mov_b32 v156, 0
    v_mov_b32 v157, 0
    v_mov_b32 v158, 0
    v_mov_b32 v159, 0
    v_mov_b32 v160, 0
    v_mov_b32 v161, 0
    v_mov_b32 v162, 0
    v_mov_b32 v163, 0
    v_mov_b32 v164, 0
    v_mov_b32 v165, 0
    v_mov_b32 v166, 0
    v_mov_b32 v167, 0
    v_mov_b32 v168, 0
    v_mov_b32 v169, 0
    v_mov_b32 v170, 0
    v_mov_b32 v171, 0
    v_mov_b32 v172, 0
    v_mov_b32 v173, 0
    v_mov_b32 v174, 0
    v_mov_b32 v175, 0
    v_mov_b32 v176, 0
    v_mov_b32 v177, 0
    v_mov_b32 v178, 0
    v_mov_b32 v179, 0
    v_mov_b32 v180, 0
    v_mov_b32 v181, 0
    v_mov_b32 v182, 0
    v_mov_b32 v183, 0
    v_mov_b32 v184, 0
    v_mov_b32 v185, 0
    v_mov_b32 v186, 0
    v_mov_b32 v187, 0
    v_mov_b32 v188, 0
    v_mov_b32 v189, 0
    v_mov_b32 v190, 0
    v_mov_b32 v191, 0
    v_mov_b32 v192, 0
    v_mov_b32 v193, 0
    v_mov_b32 v194, 0
    v_mov_b32 v195, 0
    v_mov_b32 v196, 0
    v_mov_b32 v197, 0
    v_mov_b32 v198, 0
    v_mov_b32 v199, 0
    v_mov_b32 v200, 0
    v_mov_b32 v201, 0
    v_mov_b32 v202, 0
    v_mov_b32 v203, 0
    v_mov_b32 v204, 0
    v_mov_b32 v205, 0
    v_mov_b32 v206, 0
    v_mov_b32 v207, 0
    v_mov_b32 v208, 0
    v_mov_b32 v209, 0
    v_mov_b32 v210, 0
    v_mov_b32 v211, 0
    v_mov_b32 v212, 0
    v_mov_b32 v213, 0
    v_mov_b32 v214, 0
    v_mov_b32 v215, 0
    v_mov_b32 v216, 0
    v_mov_b32 v217, 0
    v_mov_b32 v218, 0
    v_mov_b32 v219, 0
    v_mov_b32 v220, 0
    v_mov_b32 v221, 0
    v_mov_b32 v222, 0
    v_mov_b32 v223, 0
    v_mov_b32 v224, 0
    v_mov_b32 v225, 0
    v_mov_b32 v226, 0
    v_mov_b32 v227, 0
    v_mov_b32 v228, 0
    v_mov_b32 v229, 0
    v_mov_b32 v230, 0
    v_mov_b32 v231, 0
    v_mov_b32 v232, 0
    v_mov_b32 v233, 0
    v_mov_b32 v234, 0
    v_mov_b32 v235, 0
    v_mov_b32 v236, 0
    v_mov_b32 v237, 0
    v_mov_b32 v238, 0
    v_mov_b32 v239, 0
    v_mov_b32 v240, 0
    v_mov_b32 v241, 0
    v_mov_b32 v242, 0
    v_mov_b32 v243, 0
    v_mov_b32 v244, 0
    v_mov_b32 v245, 0
    v_mov_b32 v246, 0
    v_mov_b32 v247, 0
    v_mov_b32 v248, 0
    v_mov_b32 v249, 0
    v_mov_b32 v250, 0
    v_mov_b32 v251, 0
    v_mov_b32 v252, 0
    v_mov_b32 v253, 0
    v_mov_b32 v254, 0
    v_mov_b32 v255, 0
    s_waitcnt vmcnt(0)
    s_barrier
    s_cmp_ge_u32 s19, 4
    s_cbranch_scc1 g3_kernel_ypath
    s_add_u32 s36, s34, s35
    s_mov_b32 m0, s36
    s_nop 0
    buffer_load_dwordx4 v2, s[4:7], s30 offen lds
    s_add_u32 m0, s36, 1024
    s_nop 0
    buffer_load_dwordx4 v3, s[4:7], s30 offen lds
    s_add_u32 m0, s36, 2048
    s_nop 0
    buffer_load_dwordx4 v4, s[4:7], s30 offen lds
    s_add_u32 m0, s36, 3072
    s_nop 0
    buffer_load_dwordx4 v5, s[4:7], s30 offen lds
    s_add_u32 s36, s34, s44
    s_mov_b32 m0, s36
    s_nop 0
    buffer_load_dwordx4 v6, s[8:11], s31 offen lds
    s_add_u32 m0, s36, 1024
    s_nop 0
    buffer_load_dwordx4 v7, s[8:11], s31 offen lds
    s_add_u32 s36, s34, s45
    s_mov_b32 m0, s36
    s_nop 0
    buffer_load_dwordx4 v8, s[12:15], s32 offen lds
    s_add_u32 m0, s36, 1024
    s_nop 0
    buffer_load_dwordx4 v9, s[12:15], s32 offen lds
    s_add_u32 s30, s30, 128
    s_add_u32 s31, s31, 458752
    s_add_u32 s32, s32, 458752
    s_add_u32 s34, s34, 65536
    s_cmp_eq_u32 s34, 131072
    s_cselect_b32 s34, 0, s34
    ds_read_b128 v[32:35], v10 offset:0
    ds_read_b128 v[36:39], v10 offset:2048
    ds_read_b128 v[40:43], v10 offset:4096
    ds_read_b128 v[44:47], v10 offset:6144
    ds_read_b64_tr_b16 v[64:65], v12 offset:32768
    ds_read_b64_tr_b16 v[66:67], v12 offset:33792
    ds_read_b64_tr_b16 v[68:69], v13 offset:32768
    ds_read_b64_tr_b16 v[70:71], v13 offset:33792
    ds_read_b64_tr_b16 v[72:73], v14 offset:32768
    ds_read_b64_tr_b16 v[74:75], v14 offset:33792
    ds_read_b64_tr_b16 v[76:77], v15 offset:32768
    ds_read_b64_tr_b16 v[78:79], v15 offset:33792
    ds_read_b64_tr_b16 v[80:81], v16 offset:49152
    ds_read_b64_tr_b16 v[82:83], v16 offset:50176
    ds_read_b64_tr_b16 v[84:85], v17 offset:49152
    ds_read_b64_tr_b16 v[86:87], v17 offset:50176
    ds_read_b64_tr_b16 v[88:89], v18 offset:49152
    ds_read_b64_tr_b16 v[90:91], v18 offset:50176
    ds_read_b64_tr_b16 v[92:93], v19 offset:49152
    ds_read_b64_tr_b16 v[94:95], v19 offset:50176
    ds_read_b128 v[48:51], v11 offset:0
    ds_read_b128 v[52:55], v11 offset:2048
    ds_read_b128 v[56:59], v11 offset:4096
    ds_read_b128 v[60:63], v11 offset:6144
    ds_read_b64_tr_b16 v[96:97], v12 offset:40960
    ds_read_b64_tr_b16 v[98:99], v12 offset:41984
    ds_read_b64_tr_b16 v[100:101], v13 offset:40960
    ds_read_b64_tr_b16 v[102:103], v13 offset:41984
    ds_read_b64_tr_b16 v[104:105], v14 offset:40960
    ds_read_b64_tr_b16 v[106:107], v14 offset:41984
    ds_read_b64_tr_b16 v[108:109], v15 offset:40960
    ds_read_b64_tr_b16 v[110:111], v15 offset:41984
    ds_read_b64_tr_b16 v[112:113], v16 offset:57344
    ds_read_b64_tr_b16 v[114:115], v16 offset:58368
    ds_read_b64_tr_b16 v[116:117], v17 offset:57344
    ds_read_b64_tr_b16 v[118:119], v17 offset:58368
    ds_read_b64_tr_b16 v[120:121], v18 offset:57344
    ds_read_b64_tr_b16 v[122:123], v18 offset:58368
    ds_read_b64_tr_b16 v[124:125], v19 offset:57344
    ds_read_b64_tr_b16 v[126:127], v19 offset:58368
    v_xor_b32 v10, 65536, v10
    v_xor_b32 v11, 65536, v11
    v_xor_b32 v12, 65536, v12
    v_xor_b32 v13, 65536, v13
    v_xor_b32 v14, 65536, v14
    v_xor_b32 v15, 65536, v15
    v_xor_b32 v16, 65536, v16
    v_xor_b32 v17, 65536, v17
    v_xor_b32 v18, 65536, v18
    v_xor_b32 v19, 65536, v19
    s_waitcnt lgkmcnt(0)
    s_barrier
g3_kernel_xloop:
    v_mfma_f32_16x16x32_bf16 v[128:131], v[64:67], v[32:35], v[128:131]
    v_mfma_f32_16x16x32_bf16 v[132:135], v[68:71], v[32:35], v[132:135]
    v_mfma_f32_16x16x32_bf16 v[136:139], v[72:75], v[32:35], v[136:139]
    v_mfma_f32_16x16x32_bf16 v[140:143], v[76:79], v[32:35], v[140:143]
    v_mfma_f32_16x16x32_bf16 v[144:147], v[80:83], v[32:35], v[144:147]
    v_mfma_f32_16x16x32_bf16 v[148:151], v[84:87], v[32:35], v[148:151]
    v_mfma_f32_16x16x32_bf16 v[152:155], v[88:91], v[32:35], v[152:155]
    v_mfma_f32_16x16x32_bf16 v[156:159], v[92:95], v[32:35], v[156:159]
    v_mfma_f32_16x16x32_bf16 v[160:163], v[64:67], v[36:39], v[160:163]
    v_mfma_f32_16x16x32_bf16 v[164:167], v[68:71], v[36:39], v[164:167]
    v_mfma_f32_16x16x32_bf16 v[168:171], v[72:75], v[36:39], v[168:171]
    v_mfma_f32_16x16x32_bf16 v[172:175], v[76:79], v[36:39], v[172:175]
    v_mfma_f32_16x16x32_bf16 v[176:179], v[80:83], v[36:39], v[176:179]
    v_mfma_f32_16x16x32_bf16 v[180:183], v[84:87], v[36:39], v[180:183]
    v_mfma_f32_16x16x32_bf16 v[184:187], v[88:91], v[36:39], v[184:187]
    v_mfma_f32_16x16x32_bf16 v[188:191], v[92:95], v[36:39], v[188:191]
    v_mfma_f32_16x16x32_bf16 v[192:195], v[64:67], v[40:43], v[192:195]
    v_mfma_f32_16x16x32_bf16 v[196:199], v[68:71], v[40:43], v[196:199]
    v_mfma_f32_16x16x32_bf16 v[200:203], v[72:75], v[40:43], v[200:203]
    v_mfma_f32_16x16x32_bf16 v[204:207], v[76:79], v[40:43], v[204:207]
    v_mfma_f32_16x16x32_bf16 v[208:211], v[80:83], v[40:43], v[208:211]
    v_mfma_f32_16x16x32_bf16 v[212:215], v[84:87], v[40:43], v[212:215]
    v_mfma_f32_16x16x32_bf16 v[216:219], v[88:91], v[40:43], v[216:219]
    v_mfma_f32_16x16x32_bf16 v[220:223], v[92:95], v[40:43], v[220:223]
    v_mfma_f32_16x16x32_bf16 v[224:227], v[64:67], v[44:47], v[224:227]
    v_mfma_f32_16x16x32_bf16 v[228:231], v[68:71], v[44:47], v[228:231]
    v_mfma_f32_16x16x32_bf16 v[232:235], v[72:75], v[44:47], v[232:235]
    v_mfma_f32_16x16x32_bf16 v[236:239], v[76:79], v[44:47], v[236:239]
    v_mfma_f32_16x16x32_bf16 v[240:243], v[80:83], v[44:47], v[240:243]
    v_mfma_f32_16x16x32_bf16 v[244:247], v[84:87], v[44:47], v[244:247]
    v_mfma_f32_16x16x32_bf16 v[248:251], v[88:91], v[44:47], v[248:251]
    v_mfma_f32_16x16x32_bf16 v[252:255], v[92:95], v[44:47], v[252:255]
    v_mfma_f32_16x16x32_bf16 v[128:131], v[96:99], v[48:51], v[128:131]
    v_mfma_f32_16x16x32_bf16 v[132:135], v[100:103], v[48:51], v[132:135]
    v_mfma_f32_16x16x32_bf16 v[136:139], v[104:107], v[48:51], v[136:139]
    v_mfma_f32_16x16x32_bf16 v[140:143], v[108:111], v[48:51], v[140:143]
    v_mfma_f32_16x16x32_bf16 v[144:147], v[112:115], v[48:51], v[144:147]
    v_mfma_f32_16x16x32_bf16 v[148:151], v[116:119], v[48:51], v[148:151]
    v_mfma_f32_16x16x32_bf16 v[152:155], v[120:123], v[48:51], v[152:155]
    v_mfma_f32_16x16x32_bf16 v[156:159], v[124:127], v[48:51], v[156:159]
    v_mfma_f32_16x16x32_bf16 v[160:163], v[96:99], v[52:55], v[160:163]
    v_mfma_f32_16x16x32_bf16 v[164:167], v[100:103], v[52:55], v[164:167]
    v_mfma_f32_16x16x32_bf16 v[168:171], v[104:107], v[52:55], v[168:171]
    v_mfma_f32_16x16x32_bf16 v[172:175], v[108:111], v[52:55], v[172:175]
    v_mfma_f32_16x16x32_bf16 v[176:179], v[112:115], v[52:55], v[176:179]
    v_mfma_f32_16x16x32_bf16 v[180:183], v[116:119], v[52:55], v[180:183]
    v_mfma_f32_16x16x32_bf16 v[184:187], v[120:123], v[52:55], v[184:187]
    v_mfma_f32_16x16x32_bf16 v[188:191], v[124:127], v[52:55], v[188:191]
    v_mfma_f32_16x16x32_bf16 v[192:195], v[96:99], v[56:59], v[192:195]
    v_mfma_f32_16x16x32_bf16 v[196:199], v[100:103], v[56:59], v[196:199]
    v_mfma_f32_16x16x32_bf16 v[200:203], v[104:107], v[56:59], v[200:203]
    v_mfma_f32_16x16x32_bf16 v[204:207], v[108:111], v[56:59], v[204:207]
    v_mfma_f32_16x16x32_bf16 v[208:211], v[112:115], v[56:59], v[208:211]
    v_mfma_f32_16x16x32_bf16 v[212:215], v[116:119], v[56:59], v[212:215]
    v_mfma_f32_16x16x32_bf16 v[216:219], v[120:123], v[56:59], v[216:219]
    v_mfma_f32_16x16x32_bf16 v[220:223], v[124:127], v[56:59], v[220:223]
    v_mfma_f32_16x16x32_bf16 v[224:227], v[96:99], v[60:63], v[224:227]
    v_mfma_f32_16x16x32_bf16 v[228:231], v[100:103], v[60:63], v[228:231]
    v_mfma_f32_16x16x32_bf16 v[232:235], v[104:107], v[60:63], v[232:235]
    v_mfma_f32_16x16x32_bf16 v[236:239], v[108:111], v[60:63], v[236:239]
    v_mfma_f32_16x16x32_bf16 v[240:243], v[112:115], v[60:63], v[240:243]
    v_mfma_f32_16x16x32_bf16 v[244:247], v[116:119], v[60:63], v[244:247]
    v_mfma_f32_16x16x32_bf16 v[248:251], v[120:123], v[60:63], v[248:251]
    v_mfma_f32_16x16x32_bf16 v[252:255], v[124:127], v[60:63], v[252:255]
    s_waitcnt vmcnt(0)
    s_barrier
    s_add_u32 s37, s37, 1
    s_cmp_lt_u32 s37, 16
    s_cbranch_scc0 g3_kernel_xlast
    s_add_u32 s36, s34, s35
    s_mov_b32 m0, s36
    s_nop 0
    buffer_load_dwordx4 v2, s[4:7], s30 offen lds
    s_add_u32 m0, s36, 1024
    s_nop 0
    buffer_load_dwordx4 v3, s[4:7], s30 offen lds
    s_add_u32 m0, s36, 2048
    s_nop 0
    buffer_load_dwordx4 v4, s[4:7], s30 offen lds
    s_add_u32 m0, s36, 3072
    s_nop 0
    buffer_load_dwordx4 v5, s[4:7], s30 offen lds
    s_add_u32 s36, s34, s44
    s_mov_b32 m0, s36
    s_nop 0
    buffer_load_dwordx4 v6, s[8:11], s31 offen lds
    s_add_u32 m0, s36, 1024
    s_nop 0
    buffer_load_dwordx4 v7, s[8:11], s31 offen lds
    s_add_u32 s36, s34, s45
    s_mov_b32 m0, s36
    s_nop 0
    buffer_load_dwordx4 v8, s[12:15], s32 offen lds
    s_add_u32 m0, s36, 1024
    s_nop 0
    buffer_load_dwordx4 v9, s[12:15], s32 offen lds
    s_add_u32 s30, s30, 128
    s_add_u32 s31, s31, 458752
    s_add_u32 s32, s32, 458752
    s_add_u32 s34, s34, 65536
    s_cmp_eq_u32 s34, 131072
    s_cselect_b32 s34, 0, s34
    ds_read_b128 v[32:35], v10 offset:0
    ds_read_b128 v[36:39], v10 offset:2048
    ds_read_b128 v[40:43], v10 offset:4096
    ds_read_b128 v[44:47], v10 offset:6144
    ds_read_b64_tr_b16 v[64:65], v12 offset:32768
    ds_read_b64_tr_b16 v[66:67], v12 offset:33792
    ds_read_b64_tr_b16 v[68:69], v13 offset:32768
    ds_read_b64_tr_b16 v[70:71], v13 offset:33792
    ds_read_b64_tr_b16 v[72:73], v14 offset:32768
    ds_read_b64_tr_b16 v[74:75], v14 offset:33792
    ds_read_b64_tr_b16 v[76:77], v15 offset:32768
    ds_read_b64_tr_b16 v[78:79], v15 offset:33792
    ds_read_b64_tr_b16 v[80:81], v16 offset:49152
    ds_read_b64_tr_b16 v[82:83], v16 offset:50176
    ds_read_b64_tr_b16 v[84:85], v17 offset:49152
    ds_read_b64_tr_b16 v[86:87], v17 offset:50176
    ds_read_b64_tr_b16 v[88:89], v18 offset:49152
    ds_read_b64_tr_b16 v[90:91], v18 offset:50176
    ds_read_b64_tr_b16 v[92:93], v19 offset:49152
    ds_read_b64_tr_b16 v[94:95], v19 offset:50176
    ds_read_b128 v[48:51], v11 offset:0
    ds_read_b128 v[52:55], v11 offset:2048
    ds_read_b128 v[56:59], v11 offset:4096
    ds_read_b128 v[60:63], v11 offset:6144
    ds_read_b64_tr_b16 v[96:97], v12 offset:40960
    ds_read_b64_tr_b16 v[98:99], v12 offset:41984
    ds_read_b64_tr_b16 v[100:101], v13 offset:40960
    ds_read_b64_tr_b16 v[102:103], v13 offset:41984
    ds_read_b64_tr_b16 v[104:105], v14 offset:40960
    ds_read_b64_tr_b16 v[106:107], v14 offset:41984
    ds_read_b64_tr_b16 v[108:109], v15 offset:40960
    ds_read_b64_tr_b16 v[110:111], v15 offset:41984
    ds_read_b64_tr_b16 v[112:113], v16 offset:57344
    ds_read_b64_tr_b16 v[114:115], v16 offset:58368
    ds_read_b64_tr_b16 v[116:117], v17 offset:57344
    ds_read_b64_tr_b16 v[118:119], v17 offset:58368
    ds_read_b64_tr_b16 v[120:121], v18 offset:57344
    ds_read_b64_tr_b16 v[122:123], v18 offset:58368
    ds_read_b64_tr_b16 v[124:125], v19 offset:57344
    ds_read_b64_tr_b16 v[126:127], v19 offset:58368
    v_xor_b32 v10, 65536, v10
    v_xor_b32 v11, 65536, v11
    v_xor_b32 v12, 65536, v12
    v_xor_b32 v13, 65536, v13
    v_xor_b32 v14, 65536, v14
    v_xor_b32 v15, 65536, v15
    v_xor_b32 v16, 65536, v16
    v_xor_b32 v17, 65536, v17
    v_xor_b32 v18, 65536, v18
    v_xor_b32 v19, 65536, v19
    s_waitcnt lgkmcnt(0)
    s_barrier
    s_branch g3_kernel_xloop
g3_kernel_xlast:
    s_add_u32 s48, s82, 51380224
    s_addc_u32 s49, s83, 0
    s_and_b32 s49, s49, 0xffff
    s_mov_b32 s50, 524288
    s_mov_b32 s51, 0x00020000
    s_mul_i32 s25, s20, 256
    s_mul_i32 s26, s23, 64
    s_add_u32 s25, s25, s26
    v_and_b32 v68, 15, v0
    v_add_u32 v68, s25, v68
    v_lshlrev_b32 v68, 4, v68
    v_lshrrev_b32 v69, 4, v0
    v_lshlrev_b32 v69, 17, v69
    v_add_u32 v68, v68, v69
    buffer_load_dwordx4 v[72:75], v68, s[48:51], 0 offen offset:0
    buffer_load_dwordx4 v[88:91], v68, s[48:51], 0 offen offset:256
    buffer_load_dwordx4 v[104:107], v68, s[48:51], 0 offen offset:512
    buffer_load_dwordx4 v[4:7], v68, s[48:51], 0 offen offset:768
    v_add_u32 v68, 32768, v68
    buffer_load_dwordx4 v[76:79], v68, s[48:51], 0 offen offset:0
    buffer_load_dwordx4 v[92:95], v68, s[48:51], 0 offen offset:256
    buffer_load_dwordx4 v[108:111], v68, s[48:51], 0 offen offset:512
    buffer_load_dwordx4 v[8:11], v68, s[48:51], 0 offen offset:768
    v_add_u32 v68, 32768, v68
    buffer_load_dwordx4 v[80:83], v68, s[48:51], 0 offen offset:0
    buffer_load_dwordx4 v[96:99], v68, s[48:51], 0 offen offset:256
    buffer_load_dwordx4 v[112:115], v68, s[48:51], 0 offen offset:512
    buffer_load_dwordx4 v[12:15], v68, s[48:51], 0 offen offset:768
    v_add_u32 v68, 32768, v68
    buffer_load_dwordx4 v[84:87], v68, s[48:51], 0 offen offset:0
    buffer_load_dwordx4 v[100:103], v68, s[48:51], 0 offen offset:256
    buffer_load_dwordx4 v[116:119], v68, s[48:51], 0 offen offset:512
    buffer_load_dwordx4 v[16:19], v68, s[48:51], 0 offen offset:768
    s_waitcnt vmcnt(0)
    v_add_f32 v20, v72, v74
    v_add_f32 v24, v73, v75
    v_add_f32 v20, v20, v76
    v_add_f32 v24, v24, v77
    v_add_f32 v20, v20, v78
    v_add_f32 v24, v24, v79
    v_add_f32 v20, v20, v80
    v_add_f32 v24, v24, v81
    v_add_f32 v20, v20, v82
    v_add_f32 v24, v24, v83
    v_add_f32 v20, v20, v84
    v_add_f32 v24, v24, v85
    v_add_f32 v20, v20, v86
    v_add_f32 v24, v24, v87
    v_add_f32 v21, v88, v90
    v_add_f32 v25, v89, v91
    v_add_f32 v21, v21, v92
    v_add_f32 v25, v25, v93
    v_add_f32 v21, v21, v94
    v_add_f32 v25, v25, v95
    v_add_f32 v21, v21, v96
    v_add_f32 v25, v25, v97
    v_add_f32 v21, v21, v98
    v_add_f32 v25, v25, v99
    v_add_f32 v21, v21, v100
    v_add_f32 v25, v25, v101
    v_add_f32 v21, v21, v102
    v_add_f32 v25, v25, v103
    v_add_f32 v22, v104, v106
    v_add_f32 v26, v105, v107
    v_add_f32 v22, v22, v108
    v_add_f32 v26, v26, v109
    v_add_f32 v22, v22, v110
    v_add_f32 v26, v26, v111
    v_add_f32 v22, v22, v112
    v_add_f32 v26, v26, v113
    v_add_f32 v22, v22, v114
    v_add_f32 v26, v26, v115
    v_add_f32 v22, v22, v116
    v_add_f32 v26, v26, v117
    v_add_f32 v22, v22, v118
    v_add_f32 v26, v26, v119
    v_add_f32 v23, v4, v6
    v_add_f32 v27, v5, v7
    v_add_f32 v23, v23, v8
    v_add_f32 v27, v27, v9
    v_add_f32 v23, v23, v10
    v_add_f32 v27, v27, v11
    v_add_f32 v23, v23, v12
    v_add_f32 v27, v27, v13
    v_add_f32 v23, v23, v14
    v_add_f32 v27, v27, v15
    v_add_f32 v23, v23, v16
    v_add_f32 v27, v27, v17
    v_add_f32 v23, v23, v18
    v_add_f32 v27, v27, v19
    ds_swizzle_b32 v72, v20 offset:0x401F
    ds_swizzle_b32 v73, v21 offset:0x401F
    ds_swizzle_b32 v74, v22 offset:0x401F
    ds_swizzle_b32 v75, v23 offset:0x401F
    ds_swizzle_b32 v76, v24 offset:0x401F
    ds_swizzle_b32 v77, v25 offset:0x401F
    ds_swizzle_b32 v78, v26 offset:0x401F
    ds_swizzle_b32 v79, v27 offset:0x401F
    s_waitcnt lgkmcnt(0)
    v_add_f32 v20, v20, v72
    v_add_f32 v21, v21, v73
    v_add_f32 v22, v22, v74
    v_add_f32 v23, v23, v75
    v_add_f32 v24, v24, v76
    v_add_f32 v25, v25, v77
    v_add_f32 v26, v26, v78
    v_add_f32 v27, v27, v79
    v_mov_b32 v72, v20
    v_mov_b32 v73, v21
    v_mov_b32 v74, v22
    v_mov_b32 v75, v23
    v_mov_b32 v76, v24
    v_mov_b32 v77, v25
    v_mov_b32 v78, v26
    v_mov_b32 v79, v27
    s_nop 1
    v_permlane32_swap_b32 v20, v72
    v_permlane32_swap_b32 v21, v73
    v_permlane32_swap_b32 v22, v74
    v_permlane32_swap_b32 v23, v75
    v_permlane32_swap_b32 v24, v76
    v_permlane32_swap_b32 v25, v77
    v_permlane32_swap_b32 v26, v78
    v_permlane32_swap_b32 v27, v79
    s_nop 1
    v_add_f32 v20, v20, v72
    v_add_f32 v21, v21, v73
    v_add_f32 v22, v22, v74
    v_add_f32 v23, v23, v75
    v_add_f32 v24, v24, v76
    v_add_f32 v25, v25, v77
    v_add_f32 v26, v26, v78
    v_add_f32 v27, v27, v79
    v_mul_f32 v20, 0x3a800000, v20
    v_mul_f32 v24, 0x3a800000, v24
    v_mul_f32 v21, 0x3a800000, v21
    v_mul_f32 v25, 0x3a800000, v25
    v_mul_f32 v22, 0x3a800000, v22
    v_mul_f32 v26, 0x3a800000, v26
    v_mul_f32 v23, 0x3a800000, v23
    v_mul_f32 v27, 0x3a800000, v27
    v_fma_f32 v24, -v20, v20, v24
    v_fma_f32 v25, -v21, v21, v25
    v_fma_f32 v26, -v22, v22, v26
    v_fma_f32 v27, -v23, v23, v27
    v_cvt_pk_bf16_f32 v72, v20, v24
    v_cvt_pk_bf16_f32 v73, v21, v25
    v_cvt_pk_bf16_f32 v74, v22, v26
    v_cvt_pk_bf16_f32 v75, v23, v27
    v_lshlrev_b32 v20, 16, v72
    v_and_b32 v24, 0xffff0000, v72
    v_lshlrev_b32 v21, 16, v73
    v_and_b32 v25, 0xffff0000, v73
    v_lshlrev_b32 v22, 16, v74
    v_and_b32 v26, 0xffff0000, v74
    v_lshlrev_b32 v23, 16, v75
    v_and_b32 v27, 0xffff0000, v75
    v_add_f32 v24, 0x3727c5ac, v24
    v_add_f32 v25, 0x3727c5ac, v25
    v_add_f32 v26, 0x3727c5ac, v26
    v_add_f32 v27, 0x3727c5ac, v27
    v_cvt_pk_bf16_f32 v72, v24, v24
    v_cvt_pk_bf16_f32 v73, v25, v25
    v_cvt_pk_bf16_f32 v74, v26, v26
    v_cvt_pk_bf16_f32 v75, v27, v27
    v_lshlrev_b32 v24, 16, v72
    v_lshlrev_b32 v25, 16, v73
    v_lshlrev_b32 v26, 16, v74
    v_lshlrev_b32 v27, 16, v75
    v_sqrt_f32 v24, v24
    v_sqrt_f32 v25, v25
    v_sqrt_f32 v26, v26
    v_sqrt_f32 v27, v27
    s_nop 0
    v_cvt_pk_bf16_f32 v72, v24, v24
    v_cvt_pk_bf16_f32 v73, v25, v25
    v_cvt_pk_bf16_f32 v74, v26, v26
    v_cvt_pk_bf16_f32 v75, v27, v27
    v_lshlrev_b32 v24, 16, v72
    v_lshlrev_b32 v25, 16, v73
    v_lshlrev_b32 v26, 16, v74
    v_lshlrev_b32 v27, 16, v75
    v_rcp_f32 v24, v24
    v_rcp_f32 v25, v25
    v_rcp_f32 v26, v26
    v_rcp_f32 v27, v27
    s_nop 0
    v_and_b32 v68, 15, v0
    s_lshl_b32 s25, s23, 6
    v_add_u32 v68, s25, v68
    v_lshlrev_b32 v68, 3, v68
    v_add_u32 v68, 131072, v68
    v_mov_b32 v72, v20
    v_mov_b32 v73, v24
    ds_write_b64 v68, v[72:73] offset:0
    v_mov_b32 v72, v21
    v_mov_b32 v73, v25
    ds_write_b64 v68, v[72:73] offset:128
    v_mov_b32 v72, v22
    v_mov_b32 v73, v26
    ds_write_b64 v68, v[72:73] offset:256
    v_mov_b32 v72, v23
    v_mov_b32 v73, v27
    ds_write_b64 v68, v[72:73] offset:384
    s_waitcnt lgkmcnt(0)
    s_barrier
    s_branch g3_kernel_done
g3_kernel_ypath:
    s_barrier
g3_kernel_loop:
    s_add_u32 s36, s34, s35
    s_mov_b32 m0, s36
    s_nop 0
    buffer_load_dwordx4 v2, s[4:7], s30 offen lds
    s_add_u32 m0, s36, 1024
    s_nop 0
    buffer_load_dwordx4 v3, s[4:7], s30 offen lds
    s_add_u32 m0, s36, 2048
    s_nop 0
    buffer_load_dwordx4 v4, s[4:7], s30 offen lds
    s_add_u32 m0, s36, 3072
    s_nop 0
    buffer_load_dwordx4 v5, s[4:7], s30 offen lds
    s_add_u32 s36, s34, s44
    s_mov_b32 m0, s36
    s_nop 0
    buffer_load_dwordx4 v6, s[8:11], s31 offen lds
    s_add_u32 m0, s36, 1024
    s_nop 0
    buffer_load_dwordx4 v7, s[8:11], s31 offen lds
    s_add_u32 s36, s34, s45
    s_mov_b32 m0, s36
    s_nop 0
    buffer_load_dwordx4 v8, s[12:15], s32 offen lds
    s_add_u32 m0, s36, 1024
    s_nop 0
    buffer_load_dwordx4 v9, s[12:15], s32 offen lds
    s_add_u32 s30, s30, 128
    s_add_u32 s31, s31, 458752
    s_add_u32 s32, s32, 458752
    s_add_u32 s34, s34, 65536
    s_cmp_eq_u32 s34, 131072
    s_cselect_b32 s34, 0, s34
    ds_read_b128 v[32:35], v10 offset:0
    ds_read_b128 v[36:39], v10 offset:2048
    ds_read_b128 v[40:43], v10 offset:4096
    ds_read_b128 v[44:47], v10 offset:6144
    ds_read_b64_tr_b16 v[64:65], v12 offset:32768
    ds_read_b64_tr_b16 v[66:67], v12 offset:33792
    ds_read_b64_tr_b16 v[68:69], v13 offset:32768
    ds_read_b64_tr_b16 v[70:71], v13 offset:33792
    ds_read_b64_tr_b16 v[72:73], v14 offset:32768
    ds_read_b64_tr_b16 v[74:75], v14 offset:33792
    ds_read_b64_tr_b16 v[76:77], v15 offset:32768
    ds_read_b64_tr_b16 v[78:79], v15 offset:33792
    ds_read_b64_tr_b16 v[80:81], v16 offset:49152
    ds_read_b64_tr_b16 v[82:83], v16 offset:50176
    ds_read_b64_tr_b16 v[84:85], v17 offset:49152
    ds_read_b64_tr_b16 v[86:87], v17 offset:50176
    ds_read_b64_tr_b16 v[88:89], v18 offset:49152
    ds_read_b64_tr_b16 v[90:91], v18 offset:50176
    ds_read_b64_tr_b16 v[92:93], v19 offset:49152
    ds_read_b64_tr_b16 v[94:95], v19 offset:50176
    ds_read_b128 v[48:51], v11 offset:0
    ds_read_b128 v[52:55], v11 offset:2048
    ds_read_b128 v[56:59], v11 offset:4096
    ds_read_b128 v[60:63], v11 offset:6144
    ds_read_b64_tr_b16 v[96:97], v12 offset:40960
    ds_read_b64_tr_b16 v[98:99], v12 offset:41984
    ds_read_b64_tr_b16 v[100:101], v13 offset:40960
    ds_read_b64_tr_b16 v[102:103], v13 offset:41984
    ds_read_b64_tr_b16 v[104:105], v14 offset:40960
    ds_read_b64_tr_b16 v[106:107], v14 offset:41984
    ds_read_b64_tr_b16 v[108:109], v15 offset:40960
    ds_read_b64_tr_b16 v[110:111], v15 offset:41984
    ds_read_b64_tr_b16 v[112:113], v16 offset:57344
    ds_read_b64_tr_b16 v[114:115], v16 offset:58368
    ds_read_b64_tr_b16 v[116:117], v17 offset:57344
    ds_read_b64_tr_b16 v[118:119], v17 offset:58368
    ds_read_b64_tr_b16 v[120:121], v18 offset:57344
    ds_read_b64_tr_b16 v[122:123], v18 offset:58368
    ds_read_b64_tr_b16 v[124:125], v19 offset:57344
    ds_read_b64_tr_b16 v[126:127], v19 offset:58368
    v_xor_b32 v10, 65536, v10
    v_xor_b32 v11, 65536, v11
    v_xor_b32 v12, 65536, v12
    v_xor_b32 v13, 65536, v13
    v_xor_b32 v14, 65536, v14
    v_xor_b32 v15, 65536, v15
    v_xor_b32 v16, 65536, v16
    v_xor_b32 v17, 65536, v17
    v_xor_b32 v18, 65536, v18
    v_xor_b32 v19, 65536, v19
    s_waitcnt lgkmcnt(0)
    s_waitcnt vmcnt(0)
    s_barrier
    v_mfma_f32_16x16x32_bf16 v[128:131], v[64:67], v[32:35], v[128:131]
    v_mfma_f32_16x16x32_bf16 v[132:135], v[68:71], v[32:35], v[132:135]
    v_mfma_f32_16x16x32_bf16 v[136:139], v[72:75], v[32:35], v[136:139]
    v_mfma_f32_16x16x32_bf16 v[140:143], v[76:79], v[32:35], v[140:143]
    v_mfma_f32_16x16x32_bf16 v[144:147], v[80:83], v[32:35], v[144:147]
    v_mfma_f32_16x16x32_bf16 v[148:151], v[84:87], v[32:35], v[148:151]
    v_mfma_f32_16x16x32_bf16 v[152:155], v[88:91], v[32:35], v[152:155]
    v_mfma_f32_16x16x32_bf16 v[156:159], v[92:95], v[32:35], v[156:159]
    v_mfma_f32_16x16x32_bf16 v[160:163], v[64:67], v[36:39], v[160:163]
    v_mfma_f32_16x16x32_bf16 v[164:167], v[68:71], v[36:39], v[164:167]
    v_mfma_f32_16x16x32_bf16 v[168:171], v[72:75], v[36:39], v[168:171]
    v_mfma_f32_16x16x32_bf16 v[172:175], v[76:79], v[36:39], v[172:175]
    v_mfma_f32_16x16x32_bf16 v[176:179], v[80:83], v[36:39], v[176:179]
    v_mfma_f32_16x16x32_bf16 v[180:183], v[84:87], v[36:39], v[180:183]
    v_mfma_f32_16x16x32_bf16 v[184:187], v[88:91], v[36:39], v[184:187]
    v_mfma_f32_16x16x32_bf16 v[188:191], v[92:95], v[36:39], v[188:191]
    v_mfma_f32_16x16x32_bf16 v[192:195], v[64:67], v[40:43], v[192:195]
    v_mfma_f32_16x16x32_bf16 v[196:199], v[68:71], v[40:43], v[196:199]
    v_mfma_f32_16x16x32_bf16 v[200:203], v[72:75], v[40:43], v[200:203]
    v_mfma_f32_16x16x32_bf16 v[204:207], v[76:79], v[40:43], v[204:207]
    v_mfma_f32_16x16x32_bf16 v[208:211], v[80:83], v[40:43], v[208:211]
    v_mfma_f32_16x16x32_bf16 v[212:215], v[84:87], v[40:43], v[212:215]
    v_mfma_f32_16x16x32_bf16 v[216:219], v[88:91], v[40:43], v[216:219]
    v_mfma_f32_16x16x32_bf16 v[220:223], v[92:95], v[40:43], v[220:223]
    v_mfma_f32_16x16x32_bf16 v[224:227], v[64:67], v[44:47], v[224:227]
    v_mfma_f32_16x16x32_bf16 v[228:231], v[68:71], v[44:47], v[228:231]
    v_mfma_f32_16x16x32_bf16 v[232:235], v[72:75], v[44:47], v[232:235]
    v_mfma_f32_16x16x32_bf16 v[236:239], v[76:79], v[44:47], v[236:239]
    v_mfma_f32_16x16x32_bf16 v[240:243], v[80:83], v[44:47], v[240:243]
    v_mfma_f32_16x16x32_bf16 v[244:247], v[84:87], v[44:47], v[244:247]
    v_mfma_f32_16x16x32_bf16 v[248:251], v[88:91], v[44:47], v[248:251]
    v_mfma_f32_16x16x32_bf16 v[252:255], v[92:95], v[44:47], v[252:255]
    v_mfma_f32_16x16x32_bf16 v[128:131], v[96:99], v[48:51], v[128:131]
    v_mfma_f32_16x16x32_bf16 v[132:135], v[100:103], v[48:51], v[132:135]
    v_mfma_f32_16x16x32_bf16 v[136:139], v[104:107], v[48:51], v[136:139]
    v_mfma_f32_16x16x32_bf16 v[140:143], v[108:111], v[48:51], v[140:143]
    v_mfma_f32_16x16x32_bf16 v[144:147], v[112:115], v[48:51], v[144:147]
    v_mfma_f32_16x16x32_bf16 v[148:151], v[116:119], v[48:51], v[148:151]
    v_mfma_f32_16x16x32_bf16 v[152:155], v[120:123], v[48:51], v[152:155]
    v_mfma_f32_16x16x32_bf16 v[156:159], v[124:127], v[48:51], v[156:159]
    v_mfma_f32_16x16x32_bf16 v[160:163], v[96:99], v[52:55], v[160:163]
    v_mfma_f32_16x16x32_bf16 v[164:167], v[100:103], v[52:55], v[164:167]
    v_mfma_f32_16x16x32_bf16 v[168:171], v[104:107], v[52:55], v[168:171]
    v_mfma_f32_16x16x32_bf16 v[172:175], v[108:111], v[52:55], v[172:175]
    v_mfma_f32_16x16x32_bf16 v[176:179], v[112:115], v[52:55], v[176:179]
    v_mfma_f32_16x16x32_bf16 v[180:183], v[116:119], v[52:55], v[180:183]
    v_mfma_f32_16x16x32_bf16 v[184:187], v[120:123], v[52:55], v[184:187]
    v_mfma_f32_16x16x32_bf16 v[188:191], v[124:127], v[52:55], v[188:191]
    v_mfma_f32_16x16x32_bf16 v[192:195], v[96:99], v[56:59], v[192:195]
    v_mfma_f32_16x16x32_bf16 v[196:199], v[100:103], v[56:59], v[196:199]
    v_mfma_f32_16x16x32_bf16 v[200:203], v[104:107], v[56:59], v[200:203]
    v_mfma_f32_16x16x32_bf16 v[204:207], v[108:111], v[56:59], v[204:207]
    v_mfma_f32_16x16x32_bf16 v[208:211], v[112:115], v[56:59], v[208:211]
    v_mfma_f32_16x16x32_bf16 v[212:215], v[116:119], v[56:59], v[212:215]
    v_mfma_f32_16x16x32_bf16 v[216:219], v[120:123], v[56:59], v[216:219]
    v_mfma_f32_16x16x32_bf16 v[220:223], v[124:127], v[56:59], v[220:223]
    v_mfma_f32_16x16x32_bf16 v[224:227], v[96:99], v[60:63], v[224:227]
    v_mfma_f32_16x16x32_bf16 v[228:231], v[100:103], v[60:63], v[228:231]
    v_mfma_f32_16x16x32_bf16 v[232:235], v[104:107], v[60:63], v[232:235]
    v_mfma_f32_16x16x32_bf16 v[236:239], v[108:111], v[60:63], v[236:239]
    v_mfma_f32_16x16x32_bf16 v[240:243], v[112:115], v[60:63], v[240:243]
    v_mfma_f32_16x16x32_bf16 v[244:247], v[116:119], v[60:63], v[244:247]
    v_mfma_f32_16x16x32_bf16 v[248:251], v[120:123], v[60:63], v[248:251]
    v_mfma_f32_16x16x32_bf16 v[252:255], v[124:127], v[60:63], v[252:255]
    s_barrier
    s_add_u32 s37, s37, 1
    s_cmp_lt_u32 s37, 16
    s_cbranch_scc1 g3_kernel_loop
g3_kernel_done:
    s_waitcnt vmcnt(0) lgkmcnt(0)
    s_barrier
    s_nop 7
    s_add_u32 s40, s82, 29360128
    s_addc_u32 s41, s83, 0
    s_and_b32 s41, s41, 0xffff
    s_mov_b32 s42, 14680064
    s_mov_b32 s43, 0x00020000
    s_add_u32 s44, s82, 50331648
    s_addc_u32 s45, s83, 0
    s_and_b32 s45, s45, 0xffff
    s_mov_b32 s46, 28672
    s_mov_b32 s47, 0x00020000
    v_lshrrev_b32 v2, 4, v0
    v_lshlrev_b32 v2, 4, v2
    s_mul_i32 s25, s21, 512
    s_mul_i32 s26, s24, 256
    s_add_u32 s25, s25, s26
    s_add_u32 s25, s25, 0
    v_add_u32 v3, s25, v2
    buffer_load_dwordx4 v[32:35], v3, s[44:47], 0 offen
    v_add_u32 v3, 14336, v3
    buffer_load_dwordx4 v[36:39], v3, s[44:47], 0 offen
    s_mul_i32 s25, s21, 512
    s_mul_i32 s26, s24, 256
    s_add_u32 s25, s25, s26
    s_add_u32 s25, s25, 64
    v_add_u32 v3, s25, v2
    buffer_load_dwordx4 v[40:43], v3, s[44:47], 0 offen
    v_add_u32 v3, 14336, v3
    buffer_load_dwordx4 v[44:47], v3, s[44:47], 0 offen
    s_mul_i32 s25, s21, 512
    s_mul_i32 s26, s24, 256
    s_add_u32 s25, s25, s26
    s_add_u32 s25, s25, 128
    v_add_u32 v3, s25, v2
    buffer_load_dwordx4 v[48:51], v3, s[44:47], 0 offen
    v_add_u32 v3, 14336, v3
    buffer_load_dwordx4 v[52:55], v3, s[44:47], 0 offen
    s_mul_i32 s25, s21, 512
    s_mul_i32 s26, s24, 256
    s_add_u32 s25, s25, s26
    s_add_u32 s25, s25, 192
    v_add_u32 v3, s25, v2
    buffer_load_dwordx4 v[56:59], v3, s[44:47], 0 offen
    v_add_u32 v3, 14336, v3
    buffer_load_dwordx4 v[60:63], v3, s[44:47], 0 offen
    v_and_b32 v68, 15, v0
    s_lshl_b32 s25, s23, 6
    v_add_u32 v68, s25, v68
    v_lshlrev_b32 v68, 3, v68
    v_add_u32 v68, 131072, v68
    ds_read_b32 v20, v68 offset:0
    ds_read_b32 v24, v68 offset:4
    ds_read_b32 v21, v68 offset:128
    ds_read_b32 v25, v68 offset:132
    ds_read_b32 v22, v68 offset:256
    ds_read_b32 v26, v68 offset:260
    ds_read_b32 v23, v68 offset:384
    ds_read_b32 v27, v68 offset:388
    s_waitcnt vmcnt(0) lgkmcnt(0)
    s_mul_i32 s27, s19, 8192
    v_and_b32 v72, 15, v0
    v_and_b32 v73, 7, v0
    v_bfe_u32 v74, v0, 5, 1
    v_or_b32 v74, 0, v74
    v_xor_b32 v73, v73, v74
    v_lshlrev_b32 v73, 4, v73
    v_mul_u32_u24 v72, 128, v72
    v_bfe_u32 v74, v0, 4, 1
    v_lshlrev_b32 v74, 3, v74
    v_add3_u32 v72, v72, v73, v74
    v_add_u32 v72, s27, v72
    v_and_b32 v73, 15, v0
    v_and_b32 v74, 7, v0
    v_bfe_u32 v75, v0, 5, 1
    v_or_b32 v75, 2, v75
    v_xor_b32 v74, v74, v75
    v_lshlrev_b32 v74, 4, v74
    v_mul_u32_u24 v73, 128, v73
    v_bfe_u32 v75, v0, 4, 1
    v_lshlrev_b32 v75, 3, v75
    v_add3_u32 v73, v73, v74, v75
    v_add_u32 v73, s27, v73
    v_and_b32 v74, 15, v0
    v_and_b32 v75, 7, v0
    v_bfe_u32 v76, v0, 5, 1
    v_or_b32 v76, 4, v76
    v_xor_b32 v75, v75, v76
    v_lshlrev_b32 v75, 4, v75
    v_mul_u32_u24 v74, 128, v74
    v_bfe_u32 v76, v0, 4, 1
    v_lshlrev_b32 v76, 3, v76
    v_add3_u32 v74, v74, v75, v76
    v_add_u32 v74, s27, v74
    v_and_b32 v75, 15, v0
    v_and_b32 v76, 7, v0
    v_bfe_u32 v77, v0, 5, 1
    v_or_b32 v77, 6, v77
    v_xor_b32 v76, v76, v77
    v_lshlrev_b32 v76, 4, v76
    v_mul_u32_u24 v75, 128, v75
    v_bfe_u32 v77, v0, 4, 1
    v_lshlrev_b32 v77, 3, v77
    v_add3_u32 v75, v75, v76, v77
    v_add_u32 v75, s27, v75
    v_sub_f32 v8, 0, v20
    v_sub_f32 v9, 0, v20
    v_mul_f32 v10, 0xbfb8aa3b, v24
    v_mul_f32 v11, 0xbfb8aa3b, v24
    v_mul_f32 v12, v24, v24
    v_mul_f32 v13, v24, v24
    v_pk_fma_f32 v[128:129], v[8:9], v[32:33], v[128:129]
    v_pk_fma_f32 v[130:131], v[8:9], v[34:35], v[130:131]
    v_pk_mul_f32 v[4:5], v[128:129], v[10:11]
    v_pk_mul_f32 v[6:7], v[130:131], v[10:11]
    v_exp_f32 v4, v4
    v_exp_f32 v5, v5
    v_exp_f32 v6, v6
    v_exp_f32 v7, v7
    v_pk_fma_f32 v[144:145], v[8:9], v[36:37], v[144:145]
    v_pk_fma_f32 v[146:147], v[8:9], v[38:39], v[146:147]
    v_pk_add_f32 v[4:5], v[4:5], 1.0 op_sel_hi:[1,0]
    v_pk_add_f32 v[6:7], v[6:7], 1.0 op_sel_hi:[1,0]
    v_rcp_f32 v4, v4
    v_rcp_f32 v5, v5
    v_rcp_f32 v6, v6
    v_rcp_f32 v7, v7
    v_pk_mul_f32 v[128:129], v[128:129], v[144:145]
    v_pk_mul_f32 v[130:131], v[130:131], v[146:147]
    v_pk_mul_f32 v[4:5], v[4:5], v[12:13]
    v_pk_mul_f32 v[6:7], v[6:7], v[12:13]
    v_pk_mul_f32 v[128:129], v[128:129], v[4:5]
    v_pk_mul_f32 v[130:131], v[130:131], v[6:7]
    v_cvt_pk_bf16_f32 v128, v128, v129
    v_cvt_pk_bf16_f32 v129, v130, v131
    ds_write_b64 v72, v[128:129] offset:0
    v_pk_fma_f32 v[132:133], v[8:9], v[40:41], v[132:133]
    v_pk_fma_f32 v[134:135], v[8:9], v[42:43], v[134:135]
    v_pk_mul_f32 v[4:5], v[132:133], v[10:11]
    v_pk_mul_f32 v[6:7], v[134:135], v[10:11]
    v_exp_f32 v4, v4
    v_exp_f32 v5, v5
    v_exp_f32 v6, v6
    v_exp_f32 v7, v7
    v_pk_fma_f32 v[148:149], v[8:9], v[44:45], v[148:149]
    v_pk_fma_f32 v[150:151], v[8:9], v[46:47], v[150:151]
    v_pk_add_f32 v[4:5], v[4:5], 1.0 op_sel_hi:[1,0]
    v_pk_add_f32 v[6:7], v[6:7], 1.0 op_sel_hi:[1,0]
    v_rcp_f32 v4, v4
    v_rcp_f32 v5, v5
    v_rcp_f32 v6, v6
    v_rcp_f32 v7, v7
    v_pk_mul_f32 v[132:133], v[132:133], v[148:149]
    v_pk_mul_f32 v[134:135], v[134:135], v[150:151]
    v_pk_mul_f32 v[4:5], v[4:5], v[12:13]
    v_pk_mul_f32 v[6:7], v[6:7], v[12:13]
    v_pk_mul_f32 v[132:133], v[132:133], v[4:5]
    v_pk_mul_f32 v[134:135], v[134:135], v[6:7]
    v_cvt_pk_bf16_f32 v132, v132, v133
    v_cvt_pk_bf16_f32 v133, v134, v135
    ds_write_b64 v73, v[132:133] offset:0
    v_pk_fma_f32 v[136:137], v[8:9], v[48:49], v[136:137]
    v_pk_fma_f32 v[138:139], v[8:9], v[50:51], v[138:139]
    v_pk_mul_f32 v[4:5], v[136:137], v[10:11]
    v_pk_mul_f32 v[6:7], v[138:139], v[10:11]
    v_exp_f32 v4, v4
    v_exp_f32 v5, v5
    v_exp_f32 v6, v6
    v_exp_f32 v7, v7
    v_pk_fma_f32 v[152:153], v[8:9], v[52:53], v[152:153]
    v_pk_fma_f32 v[154:155], v[8:9], v[54:55], v[154:155]
    v_pk_add_f32 v[4:5], v[4:5], 1.0 op_sel_hi:[1,0]
    v_pk_add_f32 v[6:7], v[6:7], 1.0 op_sel_hi:[1,0]
    v_rcp_f32 v4, v4
    v_rcp_f32 v5, v5
    v_rcp_f32 v6, v6
    v_rcp_f32 v7, v7
    v_pk_mul_f32 v[136:137], v[136:137], v[152:153]
    v_pk_mul_f32 v[138:139], v[138:139], v[154:155]
    v_pk_mul_f32 v[4:5], v[4:5], v[12:13]
    v_pk_mul_f32 v[6:7], v[6:7], v[12:13]
    v_pk_mul_f32 v[136:137], v[136:137], v[4:5]
    v_pk_mul_f32 v[138:139], v[138:139], v[6:7]
    v_cvt_pk_bf16_f32 v136, v136, v137
    v_cvt_pk_bf16_f32 v137, v138, v139
    ds_write_b64 v74, v[136:137] offset:0
    v_pk_fma_f32 v[140:141], v[8:9], v[56:57], v[140:141]
    v_pk_fma_f32 v[142:143], v[8:9], v[58:59], v[142:143]
    v_pk_mul_f32 v[4:5], v[140:141], v[10:11]
    v_pk_mul_f32 v[6:7], v[142:143], v[10:11]
    v_exp_f32 v4, v4
    v_exp_f32 v5, v5
    v_exp_f32 v6, v6
    v_exp_f32 v7, v7
    v_pk_fma_f32 v[156:157], v[8:9], v[60:61], v[156:157]
    v_pk_fma_f32 v[158:159], v[8:9], v[62:63], v[158:159]
    v_pk_add_f32 v[4:5], v[4:5], 1.0 op_sel_hi:[1,0]
    v_pk_add_f32 v[6:7], v[6:7], 1.0 op_sel_hi:[1,0]
    v_rcp_f32 v4, v4
    v_rcp_f32 v5, v5
    v_rcp_f32 v6, v6
    v_rcp_f32 v7, v7
    v_pk_mul_f32 v[140:141], v[140:141], v[156:157]
    v_pk_mul_f32 v[142:143], v[142:143], v[158:159]
    v_pk_mul_f32 v[4:5], v[4:5], v[12:13]
    v_pk_mul_f32 v[6:7], v[6:7], v[12:13]
    v_pk_mul_f32 v[140:141], v[140:141], v[4:5]
    v_pk_mul_f32 v[142:143], v[142:143], v[6:7]
    v_cvt_pk_bf16_f32 v140, v140, v141
    v_cvt_pk_bf16_f32 v141, v142, v143
    ds_write_b64 v75, v[140:141] offset:0
    v_sub_f32 v8, 0, v21
    v_sub_f32 v9, 0, v21
    v_mul_f32 v10, 0xbfb8aa3b, v25
    v_mul_f32 v11, 0xbfb8aa3b, v25
    v_mul_f32 v12, v25, v25
    v_mul_f32 v13, v25, v25
    v_pk_fma_f32 v[160:161], v[8:9], v[32:33], v[160:161]
    v_pk_fma_f32 v[162:163], v[8:9], v[34:35], v[162:163]
    v_pk_mul_f32 v[4:5], v[160:161], v[10:11]
    v_pk_mul_f32 v[6:7], v[162:163], v[10:11]
    v_exp_f32 v4, v4
    v_exp_f32 v5, v5
    v_exp_f32 v6, v6
    v_exp_f32 v7, v7
    v_pk_fma_f32 v[176:177], v[8:9], v[36:37], v[176:177]
    v_pk_fma_f32 v[178:179], v[8:9], v[38:39], v[178:179]
    v_pk_add_f32 v[4:5], v[4:5], 1.0 op_sel_hi:[1,0]
    v_pk_add_f32 v[6:7], v[6:7], 1.0 op_sel_hi:[1,0]
    v_rcp_f32 v4, v4
    v_rcp_f32 v5, v5
    v_rcp_f32 v6, v6
    v_rcp_f32 v7, v7
    v_pk_mul_f32 v[160:161], v[160:161], v[176:177]
    v_pk_mul_f32 v[162:163], v[162:163], v[178:179]
    v_pk_mul_f32 v[4:5], v[4:5], v[12:13]
    v_pk_mul_f32 v[6:7], v[6:7], v[12:13]
    v_pk_mul_f32 v[160:161], v[160:161], v[4:5]
    v_pk_mul_f32 v[162:163], v[162:163], v[6:7]
    v_cvt_pk_bf16_f32 v160, v160, v161
    v_cvt_pk_bf16_f32 v161, v162, v163
    ds_write_b64 v72, v[160:161] offset:2048
    v_pk_fma_f32 v[164:165], v[8:9], v[40:41], v[164:165]
    v_pk_fma_f32 v[166:167], v[8:9], v[42:43], v[166:167]
    v_pk_mul_f32 v[4:5], v[164:165], v[10:11]
    v_pk_mul_f32 v[6:7], v[166:167], v[10:11]
    v_exp_f32 v4, v4
    v_exp_f32 v5, v5
    v_exp_f32 v6, v6
    v_exp_f32 v7, v7
    v_pk_fma_f32 v[180:181], v[8:9], v[44:45], v[180:181]
    v_pk_fma_f32 v[182:183], v[8:9], v[46:47], v[182:183]
    v_pk_add_f32 v[4:5], v[4:5], 1.0 op_sel_hi:[1,0]
    v_pk_add_f32 v[6:7], v[6:7], 1.0 op_sel_hi:[1,0]
    v_rcp_f32 v4, v4
    v_rcp_f32 v5, v5
    v_rcp_f32 v6, v6
    v_rcp_f32 v7, v7
    v_pk_mul_f32 v[164:165], v[164:165], v[180:181]
    v_pk_mul_f32 v[166:167], v[166:167], v[182:183]
    v_pk_mul_f32 v[4:5], v[4:5], v[12:13]
    v_pk_mul_f32 v[6:7], v[6:7], v[12:13]
    v_pk_mul_f32 v[164:165], v[164:165], v[4:5]
    v_pk_mul_f32 v[166:167], v[166:167], v[6:7]
    v_cvt_pk_bf16_f32 v164, v164, v165
    v_cvt_pk_bf16_f32 v165, v166, v167
    ds_write_b64 v73, v[164:165] offset:2048
    v_pk_fma_f32 v[168:169], v[8:9], v[48:49], v[168:169]
    v_pk_fma_f32 v[170:171], v[8:9], v[50:51], v[170:171]
    v_pk_mul_f32 v[4:5], v[168:169], v[10:11]
    v_pk_mul_f32 v[6:7], v[170:171], v[10:11]
    v_exp_f32 v4, v4
    v_exp_f32 v5, v5
    v_exp_f32 v6, v6
    v_exp_f32 v7, v7
    v_pk_fma_f32 v[184:185], v[8:9], v[52:53], v[184:185]
    v_pk_fma_f32 v[186:187], v[8:9], v[54:55], v[186:187]
    v_pk_add_f32 v[4:5], v[4:5], 1.0 op_sel_hi:[1,0]
    v_pk_add_f32 v[6:7], v[6:7], 1.0 op_sel_hi:[1,0]
    v_rcp_f32 v4, v4
    v_rcp_f32 v5, v5
    v_rcp_f32 v6, v6
    v_rcp_f32 v7, v7
    v_pk_mul_f32 v[168:169], v[168:169], v[184:185]
    v_pk_mul_f32 v[170:171], v[170:171], v[186:187]
    v_pk_mul_f32 v[4:5], v[4:5], v[12:13]
    v_pk_mul_f32 v[6:7], v[6:7], v[12:13]
    v_pk_mul_f32 v[168:169], v[168:169], v[4:5]
    v_pk_mul_f32 v[170:171], v[170:171], v[6:7]
    v_cvt_pk_bf16_f32 v168, v168, v169
    v_cvt_pk_bf16_f32 v169, v170, v171
    ds_write_b64 v74, v[168:169] offset:2048
    v_pk_fma_f32 v[172:173], v[8:9], v[56:57], v[172:173]
    v_pk_fma_f32 v[174:175], v[8:9], v[58:59], v[174:175]
    v_pk_mul_f32 v[4:5], v[172:173], v[10:11]
    v_pk_mul_f32 v[6:7], v[174:175], v[10:11]
    v_exp_f32 v4, v4
    v_exp_f32 v5, v5
    v_exp_f32 v6, v6
    v_exp_f32 v7, v7
    v_pk_fma_f32 v[188:189], v[8:9], v[60:61], v[188:189]
    v_pk_fma_f32 v[190:191], v[8:9], v[62:63], v[190:191]
    v_pk_add_f32 v[4:5], v[4:5], 1.0 op_sel_hi:[1,0]
    v_pk_add_f32 v[6:7], v[6:7], 1.0 op_sel_hi:[1,0]
    v_rcp_f32 v4, v4
    v_rcp_f32 v5, v5
    v_rcp_f32 v6, v6
    v_rcp_f32 v7, v7
    v_pk_mul_f32 v[172:173], v[172:173], v[188:189]
    v_pk_mul_f32 v[174:175], v[174:175], v[190:191]
    v_pk_mul_f32 v[4:5], v[4:5], v[12:13]
    v_pk_mul_f32 v[6:7], v[6:7], v[12:13]
    v_pk_mul_f32 v[172:173], v[172:173], v[4:5]
    v_pk_mul_f32 v[174:175], v[174:175], v[6:7]
    v_cvt_pk_bf16_f32 v172, v172, v173
    v_cvt_pk_bf16_f32 v173, v174, v175
    ds_write_b64 v75, v[172:173] offset:2048
    v_sub_f32 v8, 0, v22
    v_sub_f32 v9, 0, v22
    v_mul_f32 v10, 0xbfb8aa3b, v26
    v_mul_f32 v11, 0xbfb8aa3b, v26
    v_mul_f32 v12, v26, v26
    v_mul_f32 v13, v26, v26
    v_pk_fma_f32 v[192:193], v[8:9], v[32:33], v[192:193]
    v_pk_fma_f32 v[194:195], v[8:9], v[34:35], v[194:195]
    v_pk_mul_f32 v[4:5], v[192:193], v[10:11]
    v_pk_mul_f32 v[6:7], v[194:195], v[10:11]
    v_exp_f32 v4, v4
    v_exp_f32 v5, v5
    v_exp_f32 v6, v6
    v_exp_f32 v7, v7
    v_pk_fma_f32 v[208:209], v[8:9], v[36:37], v[208:209]
    v_pk_fma_f32 v[210:211], v[8:9], v[38:39], v[210:211]
    v_pk_add_f32 v[4:5], v[4:5], 1.0 op_sel_hi:[1,0]
    v_pk_add_f32 v[6:7], v[6:7], 1.0 op_sel_hi:[1,0]
    v_rcp_f32 v4, v4
    v_rcp_f32 v5, v5
    v_rcp_f32 v6, v6
    v_rcp_f32 v7, v7
    v_pk_mul_f32 v[192:193], v[192:193], v[208:209]
    v_pk_mul_f32 v[194:195], v[194:195], v[210:211]
    v_pk_mul_f32 v[4:5], v[4:5], v[12:13]
    v_pk_mul_f32 v[6:7], v[6:7], v[12:13]
    v_pk_mul_f32 v[192:193], v[192:193], v[4:5]
    v_pk_mul_f32 v[194:195], v[194:195], v[6:7]
    v_cvt_pk_bf16_f32 v192, v192, v193
    v_cvt_pk_bf16_f32 v193, v194, v195
    ds_write_b64 v72, v[192:193] offset:4096
    v_pk_fma_f32 v[196:197], v[8:9], v[40:41], v[196:197]
    v_pk_fma_f32 v[198:199], v[8:9], v[42:43], v[198:199]
    v_pk_mul_f32 v[4:5], v[196:197], v[10:11]
    v_pk_mul_f32 v[6:7], v[198:199], v[10:11]
    v_exp_f32 v4, v4
    v_exp_f32 v5, v5
    v_exp_f32 v6, v6
    v_exp_f32 v7, v7
    v_pk_fma_f32 v[212:213], v[8:9], v[44:45], v[212:213]
    v_pk_fma_f32 v[214:215], v[8:9], v[46:47], v[214:215]
    v_pk_add_f32 v[4:5], v[4:5], 1.0 op_sel_hi:[1,0]
    v_pk_add_f32 v[6:7], v[6:7], 1.0 op_sel_hi:[1,0]
    v_rcp_f32 v4, v4
    v_rcp_f32 v5, v5
    v_rcp_f32 v6, v6
    v_rcp_f32 v7, v7
    v_pk_mul_f32 v[196:197], v[196:197], v[212:213]
    v_pk_mul_f32 v[198:199], v[198:199], v[214:215]
    v_pk_mul_f32 v[4:5], v[4:5], v[12:13]
    v_pk_mul_f32 v[6:7], v[6:7], v[12:13]
    v_pk_mul_f32 v[196:197], v[196:197], v[4:5]
    v_pk_mul_f32 v[198:199], v[198:199], v[6:7]
    v_cvt_pk_bf16_f32 v196, v196, v197
    v_cvt_pk_bf16_f32 v197, v198, v199
    ds_write_b64 v73, v[196:197] offset:4096
    v_pk_fma_f32 v[200:201], v[8:9], v[48:49], v[200:201]
    v_pk_fma_f32 v[202:203], v[8:9], v[50:51], v[202:203]
    v_pk_mul_f32 v[4:5], v[200:201], v[10:11]
    v_pk_mul_f32 v[6:7], v[202:203], v[10:11]
    v_exp_f32 v4, v4
    v_exp_f32 v5, v5
    v_exp_f32 v6, v6
    v_exp_f32 v7, v7
    v_pk_fma_f32 v[216:217], v[8:9], v[52:53], v[216:217]
    v_pk_fma_f32 v[218:219], v[8:9], v[54:55], v[218:219]
    v_pk_add_f32 v[4:5], v[4:5], 1.0 op_sel_hi:[1,0]
    v_pk_add_f32 v[6:7], v[6:7], 1.0 op_sel_hi:[1,0]
    v_rcp_f32 v4, v4
    v_rcp_f32 v5, v5
    v_rcp_f32 v6, v6
    v_rcp_f32 v7, v7
    v_pk_mul_f32 v[200:201], v[200:201], v[216:217]
    v_pk_mul_f32 v[202:203], v[202:203], v[218:219]
    v_pk_mul_f32 v[4:5], v[4:5], v[12:13]
    v_pk_mul_f32 v[6:7], v[6:7], v[12:13]
    v_pk_mul_f32 v[200:201], v[200:201], v[4:5]
    v_pk_mul_f32 v[202:203], v[202:203], v[6:7]
    v_cvt_pk_bf16_f32 v200, v200, v201
    v_cvt_pk_bf16_f32 v201, v202, v203
    ds_write_b64 v74, v[200:201] offset:4096
    v_pk_fma_f32 v[204:205], v[8:9], v[56:57], v[204:205]
    v_pk_fma_f32 v[206:207], v[8:9], v[58:59], v[206:207]
    v_pk_mul_f32 v[4:5], v[204:205], v[10:11]
    v_pk_mul_f32 v[6:7], v[206:207], v[10:11]
    v_exp_f32 v4, v4
    v_exp_f32 v5, v5
    v_exp_f32 v6, v6
    v_exp_f32 v7, v7
    v_pk_fma_f32 v[220:221], v[8:9], v[60:61], v[220:221]
    v_pk_fma_f32 v[222:223], v[8:9], v[62:63], v[222:223]
    v_pk_add_f32 v[4:5], v[4:5], 1.0 op_sel_hi:[1,0]
    v_pk_add_f32 v[6:7], v[6:7], 1.0 op_sel_hi:[1,0]
    v_rcp_f32 v4, v4
    v_rcp_f32 v5, v5
    v_rcp_f32 v6, v6
    v_rcp_f32 v7, v7
    v_pk_mul_f32 v[204:205], v[204:205], v[220:221]
    v_pk_mul_f32 v[206:207], v[206:207], v[222:223]
    v_pk_mul_f32 v[4:5], v[4:5], v[12:13]
    v_pk_mul_f32 v[6:7], v[6:7], v[12:13]
    v_pk_mul_f32 v[204:205], v[204:205], v[4:5]
    v_pk_mul_f32 v[206:207], v[206:207], v[6:7]
    v_cvt_pk_bf16_f32 v204, v204, v205
    v_cvt_pk_bf16_f32 v205, v206, v207
    ds_write_b64 v75, v[204:205] offset:4096
    v_sub_f32 v8, 0, v23
    v_sub_f32 v9, 0, v23
    v_mul_f32 v10, 0xbfb8aa3b, v27
    v_mul_f32 v11, 0xbfb8aa3b, v27
    v_mul_f32 v12, v27, v27
    v_mul_f32 v13, v27, v27
    v_pk_fma_f32 v[224:225], v[8:9], v[32:33], v[224:225]
    v_pk_fma_f32 v[226:227], v[8:9], v[34:35], v[226:227]
    v_pk_mul_f32 v[4:5], v[224:225], v[10:11]
    v_pk_mul_f32 v[6:7], v[226:227], v[10:11]
    v_exp_f32 v4, v4
    v_exp_f32 v5, v5
    v_exp_f32 v6, v6
    v_exp_f32 v7, v7
    v_pk_fma_f32 v[240:241], v[8:9], v[36:37], v[240:241]
    v_pk_fma_f32 v[242:243], v[8:9], v[38:39], v[242:243]
    v_pk_add_f32 v[4:5], v[4:5], 1.0 op_sel_hi:[1,0]
    v_pk_add_f32 v[6:7], v[6:7], 1.0 op_sel_hi:[1,0]
    v_rcp_f32 v4, v4
    v_rcp_f32 v5, v5
    v_rcp_f32 v6, v6
    v_rcp_f32 v7, v7
    v_pk_mul_f32 v[224:225], v[224:225], v[240:241]
    v_pk_mul_f32 v[226:227], v[226:227], v[242:243]
    v_pk_mul_f32 v[4:5], v[4:5], v[12:13]
    v_pk_mul_f32 v[6:7], v[6:7], v[12:13]
    v_pk_mul_f32 v[224:225], v[224:225], v[4:5]
    v_pk_mul_f32 v[226:227], v[226:227], v[6:7]
    v_cvt_pk_bf16_f32 v224, v224, v225
    v_cvt_pk_bf16_f32 v225, v226, v227
    ds_write_b64 v72, v[224:225] offset:6144
    v_pk_fma_f32 v[228:229], v[8:9], v[40:41], v[228:229]
    v_pk_fma_f32 v[230:231], v[8:9], v[42:43], v[230:231]
    v_pk_mul_f32 v[4:5], v[228:229], v[10:11]
    v_pk_mul_f32 v[6:7], v[230:231], v[10:11]
    v_exp_f32 v4, v4
    v_exp_f32 v5, v5
    v_exp_f32 v6, v6
    v_exp_f32 v7, v7
    v_pk_fma_f32 v[244:245], v[8:9], v[44:45], v[244:245]
    v_pk_fma_f32 v[246:247], v[8:9], v[46:47], v[246:247]
    v_pk_add_f32 v[4:5], v[4:5], 1.0 op_sel_hi:[1,0]
    v_pk_add_f32 v[6:7], v[6:7], 1.0 op_sel_hi:[1,0]
    v_rcp_f32 v4, v4
    v_rcp_f32 v5, v5
    v_rcp_f32 v6, v6
    v_rcp_f32 v7, v7
    v_pk_mul_f32 v[228:229], v[228:229], v[244:245]
    v_pk_mul_f32 v[230:231], v[230:231], v[246:247]
    v_pk_mul_f32 v[4:5], v[4:5], v[12:13]
    v_pk_mul_f32 v[6:7], v[6:7], v[12:13]
    v_pk_mul_f32 v[228:229], v[228:229], v[4:5]
    v_pk_mul_f32 v[230:231], v[230:231], v[6:7]
    v_cvt_pk_bf16_f32 v228, v228, v229
    v_cvt_pk_bf16_f32 v229, v230, v231
    ds_write_b64 v73, v[228:229] offset:6144
    v_pk_fma_f32 v[232:233], v[8:9], v[48:49], v[232:233]
    v_pk_fma_f32 v[234:235], v[8:9], v[50:51], v[234:235]
    v_pk_mul_f32 v[4:5], v[232:233], v[10:11]
    v_pk_mul_f32 v[6:7], v[234:235], v[10:11]
    v_exp_f32 v4, v4
    v_exp_f32 v5, v5
    v_exp_f32 v6, v6
    v_exp_f32 v7, v7
    v_pk_fma_f32 v[248:249], v[8:9], v[52:53], v[248:249]
    v_pk_fma_f32 v[250:251], v[8:9], v[54:55], v[250:251]
    v_pk_add_f32 v[4:5], v[4:5], 1.0 op_sel_hi:[1,0]
    v_pk_add_f32 v[6:7], v[6:7], 1.0 op_sel_hi:[1,0]
    v_rcp_f32 v4, v4
    v_rcp_f32 v5, v5
    v_rcp_f32 v6, v6
    v_rcp_f32 v7, v7
    v_pk_mul_f32 v[232:233], v[232:233], v[248:249]
    v_pk_mul_f32 v[234:235], v[234:235], v[250:251]
    v_pk_mul_f32 v[4:5], v[4:5], v[12:13]
    v_pk_mul_f32 v[6:7], v[6:7], v[12:13]
    v_pk_mul_f32 v[232:233], v[232:233], v[4:5]
    v_pk_mul_f32 v[234:235], v[234:235], v[6:7]
    v_cvt_pk_bf16_f32 v232, v232, v233
    v_cvt_pk_bf16_f32 v233, v234, v235
    ds_write_b64 v74, v[232:233] offset:6144
    v_pk_fma_f32 v[236:237], v[8:9], v[56:57], v[236:237]
    v_pk_fma_f32 v[238:239], v[8:9], v[58:59], v[238:239]
    v_pk_mul_f32 v[4:5], v[236:237], v[10:11]
    v_pk_mul_f32 v[6:7], v[238:239], v[10:11]
    v_exp_f32 v4, v4
    v_exp_f32 v5, v5
    v_exp_f32 v6, v6
    v_exp_f32 v7, v7
    v_pk_fma_f32 v[252:253], v[8:9], v[60:61], v[252:253]
    v_pk_fma_f32 v[254:255], v[8:9], v[62:63], v[254:255]
    v_pk_add_f32 v[4:5], v[4:5], 1.0 op_sel_hi:[1,0]
    v_pk_add_f32 v[6:7], v[6:7], 1.0 op_sel_hi:[1,0]
    v_rcp_f32 v4, v4
    v_rcp_f32 v5, v5
    v_rcp_f32 v6, v6
    v_rcp_f32 v7, v7
    v_pk_mul_f32 v[236:237], v[236:237], v[252:253]
    v_pk_mul_f32 v[238:239], v[238:239], v[254:255]
    v_pk_mul_f32 v[4:5], v[4:5], v[12:13]
    v_pk_mul_f32 v[6:7], v[6:7], v[12:13]
    v_pk_mul_f32 v[236:237], v[236:237], v[4:5]
    v_pk_mul_f32 v[238:239], v[238:239], v[6:7]
    v_cvt_pk_bf16_f32 v236, v236, v237
    v_cvt_pk_bf16_f32 v237, v238, v239
    ds_write_b64 v75, v[236:237] offset:6144
    s_waitcnt lgkmcnt(0)
    v_lshrrev_b32 v78, 3, v0
    v_and_b32 v79, 7, v0
    v_and_b32 v80, 7, v78
    v_xor_b32 v80, v80, v79
    v_lshlrev_b32 v80, 4, v80
    v_mul_u32_u24 v81, 128, v78
    v_add3_u32 v80, v80, v81, s27
    s_mul_i32 s25, s20, 256
    s_mul_i32 s26, s23, 64
    s_add_u32 s25, s25, s26
    v_add_u32 v78, s25, v78
    s_mov_b32 s26, 7168
    v_mul_lo_u32 v78, v78, s26
    v_lshlrev_b32 v79, 4, v79
    s_mul_i32 s25, s21, 256
    s_mul_i32 s26, s24, 128
    s_add_u32 s25, s25, s26
    v_add3_u32 v78, v78, v79, s25
    ds_read_b128 v[88:91], v80 offset:0
    ds_read_b128 v[92:95], v80 offset:1024
    ds_read_b128 v[96:99], v80 offset:2048
    ds_read_b128 v[100:103], v80 offset:3072
    ds_read_b128 v[104:107], v80 offset:4096
    ds_read_b128 v[108:111], v80 offset:5120
    ds_read_b128 v[112:115], v80 offset:6144
    ds_read_b128 v[116:119], v80 offset:7168
    s_waitcnt lgkmcnt(7)
    buffer_store_dwordx4 v[88:91], v78, s[40:43], 0 offen sc1
    s_waitcnt lgkmcnt(6)
    v_add_u32 v78, 57344, v78
    buffer_store_dwordx4 v[92:95], v78, s[40:43], 0 offen sc1
    s_waitcnt lgkmcnt(5)
    v_add_u32 v78, 57344, v78
    buffer_store_dwordx4 v[96:99], v78, s[40:43], 0 offen sc1
    s_waitcnt lgkmcnt(4)
    v_add_u32 v78, 57344, v78
    buffer_store_dwordx4 v[100:103], v78, s[40:43], 0 offen sc1
    s_waitcnt lgkmcnt(3)
    v_add_u32 v78, 57344, v78
    buffer_store_dwordx4 v[104:107], v78, s[40:43], 0 offen sc1
    s_waitcnt lgkmcnt(2)
    v_add_u32 v78, 57344, v78
    buffer_store_dwordx4 v[108:111], v78, s[40:43], 0 offen sc1
    s_waitcnt lgkmcnt(1)
    v_add_u32 v78, 57344, v78
    buffer_store_dwordx4 v[112:115], v78, s[40:43], 0 offen sc1
    s_waitcnt lgkmcnt(0)
    v_add_u32 v78, 57344, v78
    buffer_store_dwordx4 v[116:119], v78, s[40:43], 0 offen sc1
    s_nop 1
g3_kernel_end:
    s_endpgm
.globl g4_kernel
.p2align 8
.type g4_kernel,@function
g4_kernel:
    s_cmp_ge_u32 s2, 256
    s_cbranch_scc1 g4_kernel_end
    s_load_dwordx16 s[64:79], s[0:1], 0
    s_load_dwordx4 s[80:83], s[0:1], 64
    s_waitcnt lgkmcnt(0)
    s_add_u32 s4, s82, 29360128
    s_addc_u32 s5, s83, 0
    s_and_b32 s5, s5, 0xffff
    s_mov_b32 s6, 14680064
    s_mov_b32 s7, 0x00020000
    s_mov_b32 s8, s76
    s_and_b32 s9, s77, 0xffff
    s_mov_b32 s10, 7340032
    s_mov_b32 s11, 0x00020000
    s_and_b32 s25, s2, 7
    s_lshr_b32 s26, s2, 3
    s_and_b32 s20, s25, 3
    s_mul_i32 s20, s20, 4
    s_and_b32 s27, s26, 3
    s_add_u32 s20, s20, s27
    s_lshr_b32 s21, s25, 2
    s_mul_i32 s21, s21, 8
    s_lshr_b32 s27, s26, 2
    s_add_u32 s21, s21, s27
    v_lshrrev_b32 v1, 6, v0
    s_nop 0
    v_readfirstlane_b32 s19, v1
    s_and_b32 s23, s19, 1
    s_lshr_b32 s24, s19, 1
    s_and_b32 s24, s24, 1
    s_sub_u32 s22, s19, 4
    s_and_b32 s22, s22, 3
    v_and_b32 v0, 63, v0
    v_lshrrev_b32 v1, 3, v0
    v_and_b32 v32, 7, v0
    v_xor_b32 v32, v32, v1
    v_lshlrev_b32 v32, 4, v32
    s_mul_i32 s25, s22, 32
    s_mul_i32 s26, s20, 128
    s_add_u32 s25, s25, s26
    v_add_u32 v1, s25, v1
    s_mov_b32 s26, 7168
    v_mul_lo_u32 v1, v1, s26
    v_add_u32 v2, v1, v32
    v_add_u32 v3, 57344, v2
    v_add_u32 v4, 114688, v2
    v_add_u32 v5, 172032, v2
    s_mul_i32 s25, s22, 16
    s_add_u32 s25, s25, 0
    v_lshrrev_b32 v1, 3, v0
    v_add_u32 v1, s25, v1
    v_bfe_u32 v32, v1, 1, 1
    v_lshrrev_b32 v33, 2, v1
    v_and_b32 v33, 2, v33
    v_or_b32 v32, v32, v33
    v_lshlrev_b32 v32, 1, v32
    v_and_b32 v33, 7, v0
    v_xor_b32 v32, v32, v33
    v_lshlrev_b32 v32, 4, v32
    s_mov_b32 s26, 2048
    v_mul_lo_u32 v1, v1, s26
    v_add_u32 v1, v1, v32
    s_mul_i32 s26, s21, 128
    v_add_u32 v6, s26, v1
    s_mul_i32 s25, s22, 16
    s_add_u32 s25, s25, 8
    v_lshrrev_b32 v1, 3, v0
    v_add_u32 v1, s25, v1
    v_bfe_u32 v32, v1, 1, 1
    v_lshrrev_b32 v33, 2, v1
    v_and_b32 v33, 2, v33
    v_or_b32 v32, v32, v33
    v_lshlrev_b32 v32, 1, v32
    v_and_b32 v33, 7, v0
    v_xor_b32 v32, v32, v33
    v_lshlrev_b32 v32, 4, v32
    s_mov_b32 s26, 2048
    v_mul_lo_u32 v1, v1, s26
    v_add_u32 v1, v1, v32
    s_mul_i32 s26, s21, 128
    v_add_u32 v7, s26, v1
    s_mov_b32 s30, 0
    s_mov_b32 s31, 0
    s_mov_b32 s34, 0
    s_mul_i32 s35, s22, 4096
    s_mul_i32 s44, s22, 2048
    s_add_u32 s44, s44, 16384
    s_mov_b32 s37, 0
    s_cmp_lt_u32 s19, 4
    s_cbranch_scc1 g4_kernel_comp
    s_add_u32 s36, s34, s35
    s_mov_b32 m0, s36
    s_nop 0
    buffer_load_dwordx4 v2, s[4:7], s30 offen lds
    s_add_u32 m0, s36, 1024
    s_nop 0
    buffer_load_dwordx4 v3, s[4:7], s30 offen lds
    s_add_u32 m0, s36, 2048
    s_nop 0
    buffer_load_dwordx4 v4, s[4:7], s30 offen lds
    s_add_u32 m0, s36, 3072
    s_nop 0
    buffer_load_dwordx4 v5, s[4:7], s30 offen lds
    s_add_u32 s36, s34, s44
    s_mov_b32 m0, s36
    s_nop 0
    buffer_load_dwordx4 v6, s[8:11], s31 offen lds
    s_add_u32 m0, s36, 1024
    s_nop 0
    buffer_load_dwordx4 v7, s[8:11], s31 offen lds
    s_add_u32 s30, s30, 128
    s_add_u32 s31, s31, 131072
    s_add_u32 s34, s34, 24576
    s_cmp_eq_u32 s34, 147456
    s_cselect_b32 s34, 0, s34
    s_add_u32 s36, s34, s35
    s_mov_b32 m0, s36
    s_nop 0
    buffer_load_dwordx4 v2, s[4:7], s30 offen lds
    s_add_u32 m0, s36, 1024
    s_nop 0
    buffer_load_dwordx4 v3, s[4:7], s30 offen lds
    s_add_u32 m0, s36, 2048
    s_nop 0
    buffer_load_dwordx4 v4, s[4:7], s30 offen lds
    s_add_u32 m0, s36, 3072
    s_nop 0
    buffer_load_dwordx4 v5, s[4:7], s30 offen lds
    s_add_u32 s36, s34, s44
    s_mov_b32 m0, s36
    s_nop 0
    buffer_load_dwordx4 v6, s[8:11], s31 offen lds
    s_add_u32 m0, s36, 1024
    s_nop 0
    buffer_load_dwordx4 v7, s[8:11], s31 offen lds
    s_add_u32 s30, s30, 128
    s_add_u32 s31, s31, 131072
    s_add_u32 s34, s34, 24576
    s_cmp_eq_u32 s34, 147456
    s_cselect_b32 s34, 0, s34
    s_add_u32 s36, s34, s35
    s_mov_b32 m0, s36
    s_nop 0
    buffer_load_dwordx4 v2, s[4:7], s30 offen lds
    s_add_u32 m0, s36, 1024
    s_nop 0
    buffer_load_dwordx4 v3, s[4:7], s30 offen lds
    s_add_u32 m0, s36, 2048
    s_nop 0
    buffer_load_dwordx4 v4, s[4:7], s30 offen lds
    s_add_u32 m0, s36, 3072
    s_nop 0
    buffer_load_dwordx4 v5, s[4:7], s30 offen lds
    s_add_u32 s36, s34, s44
    s_mov_b32 m0, s36
    s_nop 0
    buffer_load_dwordx4 v6, s[8:11], s31 offen lds
    s_add_u32 m0, s36, 1024
    s_nop 0
    buffer_load_dwordx4 v7, s[8:11], s31 offen lds
    s_add_u32 s30, s30, 128
    s_add_u32 s31, s31, 131072
    s_add_u32 s34, s34, 24576
    s_cmp_eq_u32 s34, 147456
    s_cselect_b32 s34, 0, s34
    s_add_u32 s36, s34, s35
    s_mov_b32 m0, s36
    s_nop 0
    buffer_load_dwordx4 v2, s[4:7], s30 offen lds
    s_add_u32 m0, s36, 1024
    s_nop 0
    buffer_load_dwordx4 v3, s[4:7], s30 offen lds
    s_add_u32 m0, s36, 2048
    s_nop 0
    buffer_load_dwordx4 v4, s[4:7], s30 offen lds
    s_add_u32 m0, s36, 3072
    s_nop 0
    buffer_load_dwordx4 v5, s[4:7], s30 offen lds
    s_add_u32 s36, s34, s44
    s_mov_b32 m0, s36
    s_nop 0
    buffer_load_dwordx4 v6, s[8:11], s31 offen lds
    s_add_u32 m0, s36, 1024
    s_nop 0
    buffer_load_dwordx4 v7, s[8:11], s31 offen lds
    s_add_u32 s30, s30, 128
    s_add_u32 s31, s31, 131072
    s_add_u32 s34, s34, 24576
    s_cmp_eq_u32 s34, 147456
    s_cselect_b32 s34, 0, s34
    s_add_u32 s36, s34, s35
    s_mov_b32 m0, s36
    s_nop 0
    buffer_load_dwordx4 v2, s[4:7], s30 offen lds
    s_add_u32 m0, s36, 1024
    s_nop 0
    buffer_load_dwordx4 v3, s[4:7], s30 offen lds
    s_add_u32 m0, s36, 2048
    s_nop 0
    buffer_load_dwordx4 v4, s[4:7], s30 offen lds
    s_add_u32 m0, s36, 3072
    s_nop 0
    buffer_load_dwordx4 v5, s[4:7], s30 offen lds
    s_add_u32 s36, s34, s44
    s_mov_b32 m0, s36
    s_nop 0
    buffer_load_dwordx4 v6, s[8:11], s31 offen lds
    s_add_u32 m0, s36, 1024
    s_nop 0
    buffer_load_dwordx4 v7, s[8:11], s31 offen lds
    s_add_u32 s30, s30, 128
    s_add_u32 s31, s31, 131072
    s_add_u32 s34, s34, 24576
    s_cmp_eq_u32 s34, 147456
    s_cselect_b32 s34, 0, s34
    s_waitcnt vmcnt(24)
    s_barrier
g4_kernel_lloop:
    s_waitcnt vmcnt(18)
    s_barrier
    s_add_u32 s36, s34, s35
    s_mov_b32 m0, s36
    s_nop 0
    buffer_load_dwordx4 v2, s[4:7], s30 offen lds
    s_add_u32 m0, s36, 1024
    s_nop 0
    buffer_load_dwordx4 v3, s[4:7], s30 offen lds
    s_add_u32 m0, s36, 2048
    s_nop 0
    buffer_load_dwordx4 v4, s[4:7], s30 offen lds
    s_add_u32 m0, s36, 3072
    s_nop 0
    buffer_load_dwordx4 v5, s[4:7], s30 offen lds
    s_add_u32 s36, s34, s44
    s_mov_b32 m0, s36
    s_nop 0
    buffer_load_dwordx4 v6, s[8:11], s31 offen lds
    s_add_u32 m0, s36, 1024
    s_nop 0
    buffer_load_dwordx4 v7, s[8:11], s31 offen lds
    s_add_u32 s30, s30, 128
    s_add_u32 s31, s31, 131072
    s_add_u32 s34, s34, 24576
    s_cmp_eq_u32 s34, 147456
    s_cselect_b32 s34, 0, s34
    s_add_u32 s37, s37, 1
    s_cmp_lt_u32 s37, 56
    s_cbranch_scc1 g4_kernel_lloop
    s_waitcnt vmcnt(0)
    s_endpgm
g4_kernel_comp:
    v_and_b32 v1, 15, v0
    v_lshlrev_b32 v1, 7, v1
    v_lshrrev_b32 v32, 4, v0
    v_and_b32 v33, 7, v0
    s_mul_i32 s25, s23, 8192
    v_add_u32 v1, s25, v1
    v_xor_b32 v34, v32, v33
    v_lshlrev_b32 v34, 4, v34
    v_add_u32 v8, v1, v34
    v_or_b32 v32, 4, v32
    v_xor_b32 v34, v32, v33
    v_lshlrev_b32 v34, 4, v34
    v_add_u32 v9, v1, v34
    v_lshrrev_b32 v1, 4, v0
    v_lshlrev_b32 v1, 3, v1
    v_bfe_u32 v32, v0, 2, 2
    v_add_u32 v1, v1, v32
    v_bfe_u32 v33, v0, 3, 1
    v_bfe_u32 v34, v0, 4, 1
    v_lshlrev_b32 v34, 1, v34
    v_or_b32 v33, v33, v34
    s_mul_i32 s25, s24, 2
    s_add_u32 s25, s25, 0
    v_xor_b32 v33, s25, v33
    v_lshlrev_b32 v33, 5, v33
    s_mov_b32 s26, 128
    v_mul_lo_u32 v1, v1, s26
    v_and_b32 v34, 3, v0
    v_lshlrev_b32 v34, 3, v34
    v_add3_u32 v10, v1, v33, v34
    v_lshrrev_b32 v1, 4, v0
    v_lshlrev_b32 v1, 3, v1
    v_bfe_u32 v32, v0, 2, 2
    v_add_u32 v1, v1, v32
    v_bfe_u32 v33, v0, 3, 1
    v_bfe_u32 v34, v0, 4, 1
    v_lshlrev_b32 v34, 1, v34
    v_or_b32 v33, v33, v34
    s_mul_i32 s25, s24, 2
    s_add_u32 s25, s25, 1
    v_xor_b32 v33, s25, v33
    v_lshlrev_b32 v33, 5, v33
    s_mov_b32 s26, 128
    v_mul_lo_u32 v1, v1, s26
    v_and_b32 v34, 3, v0
    v_lshlrev_b32 v34, 3, v34
    v_add3_u32 v11, v1, v33, v34
    v_mov_b32 v80, 0
    v_mov_b32 v81, 0
    v_mov_b32 v82, 0
    v_mov_b32 v83, 0
    v_mov_b32 v84, 0
    v_mov_b32 v85, 0
    v_mov_b32 v86, 0
    v_mov_b32 v87, 0
    v_mov_b32 v88, 0
    v_mov_b32 v89, 0
    v_mov_b32 v90, 0
    v_mov_b32 v91, 0
    v_mov_b32 v92, 0
    v_mov_b32 v93, 0
    v_mov_b32 v94, 0
    v_mov_b32 v95, 0
    v_mov_b32 v96, 0
    v_mov_b32 v97, 0
    v_mov_b32 v98, 0
    v_mov_b32 v99, 0
    v_mov_b32 v100, 0
    v_mov_b32 v101, 0
    v_mov_b32 v102, 0
    v_mov_b32 v103, 0
    v_mov_b32 v104, 0
    v_mov_b32 v105, 0
    v_mov_b32 v106, 0
    v_mov_b32 v107, 0
    v_mov_b32 v108, 0
    v_mov_b32 v109, 0
    v_mov_b32 v110, 0
    v_mov_b32 v111, 0
    s_add_u32 s48, s82, 20971520
    s_addc_u32 s49, s83, 0
    s_and_b32 s49, s49, 0xffff
    s_mov_b32 s50, 4194304
    s_mov_b32 s51, 0x00020000
    s_mul_i32 s25, s20, 128
    s_mul_i32 s26, s23, 64
    s_add_u32 s25, s25, s26
    v_and_b32 v32, 15, v0
    v_add_u32 v32, s25, v32
    s_mov_b32 s26, 2048
    v_mul_lo_u32 v32, v32, s26
    v_lshrrev_b32 v33, 4, v0
    v_lshlrev_b32 v33, 3, v33
    v_add_u32 v32, v32, v33
    s_mul_i32 s25, s21, 128
    s_mul_i32 s26, s24, 64
    s_add_u32 s25, s25, s26
    s_add_u32 s25, s25, 0
    v_add_u32 v34, s25, v32
    buffer_load_dwordx2 v[16:17], v34, s[48:51], 0 offen
    v_add_u32 v34, s25, v32
    v_add_u32 v34, 32768, v34
    buffer_load_dwordx2 v[20:21], v34, s[48:51], 0 offen
    v_add_u32 v34, s25, v32
    v_add_u32 v34, 65536, v34
    buffer_load_dwordx2 v[24:25], v34, s[48:51], 0 offen
    v_add_u32 v34, s25, v32
    v_add_u32 v34, 98304, v34
    buffer_load_dwordx2 v[28:29], v34, s[48:51], 0 offen
    s_mul_i32 s25, s21, 128
    s_mul_i32 s26, s24, 64
    s_add_u32 s25, s25, s26
    s_add_u32 s25, s25, 32
    v_add_u32 v34, s25, v32
    buffer_load_dwordx2 v[18:19], v34, s[48:51], 0 offen
    v_add_u32 v34, s25, v32
    v_add_u32 v34, 32768, v34
    buffer_load_dwordx2 v[22:23], v34, s[48:51], 0 offen
    v_add_u32 v34, s25, v32
    v_add_u32 v34, 65536, v34
    buffer_load_dwordx2 v[26:27], v34, s[48:51], 0 offen
    v_add_u32 v34, s25, v32
    v_add_u32 v34, 98304, v34
    buffer_load_dwordx2 v[30:31], v34, s[48:51], 0 offen
    s_mov_b32 s38, 0
    v_add_u32 v12, s38, v8
    v_add_u32 v13, s38, v9
    v_add_u32 v14, s38, v10
    v_add_u32 v15, s38, v11
    s_add_u32 s38, s38, 24576
    s_cmp_eq_u32 s38, 147456
    s_cselect_b32 s38, 0, s38
    s_barrier
    ds_read_b128 v[32:35], v12 offset:0
    ds_read_b128 v[36:39], v12 offset:2048
    ds_read_b128 v[40:43], v12 offset:4096
    ds_read_b128 v[44:47], v12 offset:6144
    ds_read_b64_tr_b16 v[64:65], v14 offset:16384
    ds_read_b64_tr_b16 v[66:67], v14 offset:16896
    ds_read_b64_tr_b16 v[68:69], v15 offset:16384
    ds_read_b64_tr_b16 v[70:71], v15 offset:16896
g4_kernel_loop:
    s_waitcnt lgkmcnt(0)
    v_mfma_f32_16x16x32_bf16 v[80:83], v[64:67], v[32:35], v[80:83]
    ds_read_b128 v[48:51], v13 offset:0
    v_mfma_f32_16x16x32_bf16 v[84:87], v[68:71], v[32:35], v[84:87]
    ds_read_b128 v[52:55], v13 offset:2048
    v_mfma_f32_16x16x32_bf16 v[88:91], v[64:67], v[36:39], v[88:91]
    ds_read_b128 v[56:59], v13 offset:4096
    v_mfma_f32_16x16x32_bf16 v[92:95], v[68:71], v[36:39], v[92:95]
    ds_read_b128 v[60:63], v13 offset:6144
    v_mfma_f32_16x16x32_bf16 v[96:99], v[64:67], v[40:43], v[96:99]
    ds_read_b64_tr_b16 v[72:73], v14 offset:20480
    v_mfma_f32_16x16x32_bf16 v[100:103], v[68:71], v[40:43], v[100:103]
    ds_read_b64_tr_b16 v[74:75], v14 offset:20992
    v_mfma_f32_16x16x32_bf16 v[104:107], v[64:67], v[44:47], v[104:107]
    ds_read_b64_tr_b16 v[76:77], v15 offset:20480
    v_mfma_f32_16x16x32_bf16 v[108:111], v[68:71], v[44:47], v[108:111]
    ds_read_b64_tr_b16 v[78:79], v15 offset:20992
    s_barrier
    s_waitcnt lgkmcnt(0)
    v_mfma_f32_16x16x32_bf16 v[80:83], v[72:75], v[48:51], v[80:83]
    v_add_u32 v12, s38, v8
    v_add_u32 v13, s38, v9
    v_mfma_f32_16x16x32_bf16 v[84:87], v[76:79], v[48:51], v[84:87]
    v_add_u32 v14, s38, v10
    v_add_u32 v15, s38, v11
    s_add_u32 s38, s38, 24576
    s_cmp_eq_u32 s38, 147456
    s_cselect_b32 s38, 0, s38
    v_mfma_f32_16x16x32_bf16 v[88:91], v[72:75], v[52:55], v[88:91]
    ds_read_b128 v[32:35], v12 offset:0
    ds_read_b128 v[36:39], v12 offset:2048
    v_mfma_f32_16x16x32_bf16 v[92:95], v[76:79], v[52:55], v[92:95]
    ds_read_b128 v[40:43], v12 offset:4096
    ds_read_b128 v[44:47], v12 offset:6144
    v_mfma_f32_16x16x32_bf16 v[96:99], v[72:75], v[56:59], v[96:99]
    ds_read_b64_tr_b16 v[64:65], v14 offset:16384
    ds_read_b64_tr_b16 v[66:67], v14 offset:16896
    v_mfma_f32_16x16x32_bf16 v[100:103], v[76:79], v[56:59], v[100:103]
    ds_read_b64_tr_b16 v[68:69], v15 offset:16384
    ds_read_b64_tr_b16 v[70:71], v15 offset:16896
    v_mfma_f32_16x16x32_bf16 v[104:107], v[72:75], v[60:63], v[104:107]
    v_mfma_f32_16x16x32_bf16 v[108:111], v[76:79], v[60:63], v[108:111]
    s_add_u32 s37, s37, 1
    s_cmp_lt_u32 s37, 56
    s_cbranch_scc1 g4_kernel_loop
g4_kernel_done:
    s_waitcnt vmcnt(0) lgkmcnt(0)
    s_nop 7
    s_mov_b32 s40, s78
    s_and_b32 s41, s79, 0xffff
    s_mov_b32 s42, 4194304
    s_mov_b32 s43, 0x00020000
    s_mul_i32 s25, s20, 128
    s_mul_i32 s26, s23, 64
    s_add_u32 s25, s25, s26
    v_and_b32 v1, 15, v0
    v_add_u32 v1, s25, v1
    s_mov_b32 s26, 2048
    v_mul_lo_u32 v1, v1, s26
    v_lshrrev_b32 v2, 4, v0
    v_lshlrev_b32 v2, 3, v2
    v_add_u32 v1, v1, v2
    s_mul_i32 s25, s21, 128
    s_mul_i32 s26, s24, 64
    s_add_u32 s25, s25, s26
    s_add_u32 s25, s25, 0
    v_add_u32 v3, s25, v1
    v_cvt_pk_bf16_f32 v80, v80, v81
    v_cvt_pk_bf16_f32 v81, v82, v83
    v_lshlrev_b32 v6, 16, v80
    v_and_b32 v7, 0xffff0000, v80
    v_lshlrev_b32 v8, 16, v16
    v_and_b32 v9, 0xffff0000, v16
    v_add_f32 v6, v6, v8
    v_add_f32 v7, v7, v9
    v_cvt_pk_bf16_f32 v80, v6, v7
    v_lshlrev_b32 v6, 16, v81
    v_and_b32 v7, 0xffff0000, v81
    v_lshlrev_b32 v8, 16, v17
    v_and_b32 v9, 0xffff0000, v17
    v_add_f32 v6, v6, v8
    v_add_f32 v7, v7, v9
    v_cvt_pk_bf16_f32 v81, v6, v7
    v_add_u32 v4, 0, v3
    buffer_store_dwordx2 v[80:81], v4, s[40:43], 0 offen
    v_cvt_pk_bf16_f32 v88, v88, v89
    v_cvt_pk_bf16_f32 v89, v90, v91
    v_lshlrev_b32 v6, 16, v88
    v_and_b32 v7, 0xffff0000, v88
    v_lshlrev_b32 v8, 16, v20
    v_and_b32 v9, 0xffff0000, v20
    v_add_f32 v6, v6, v8
    v_add_f32 v7, v7, v9
    v_cvt_pk_bf16_f32 v88, v6, v7
    v_lshlrev_b32 v6, 16, v89
    v_and_b32 v7, 0xffff0000, v89
    v_lshlrev_b32 v8, 16, v21
    v_and_b32 v9, 0xffff0000, v21
    v_add_f32 v6, v6, v8
    v_add_f32 v7, v7, v9
    v_cvt_pk_bf16_f32 v89, v6, v7
    v_add_u32 v4, 32768, v3
    buffer_store_dwordx2 v[88:89], v4, s[40:43], 0 offen
    v_cvt_pk_bf16_f32 v96, v96, v97
    v_cvt_pk_bf16_f32 v97, v98, v99
    v_lshlrev_b32 v6, 16, v96
    v_and_b32 v7, 0xffff0000, v96
    v_lshlrev_b32 v8, 16, v24
    v_and_b32 v9, 0xffff0000, v24
    v_add_f32 v6, v6, v8
    v_add_f32 v7, v7, v9
    v_cvt_pk_bf16_f32 v96, v6, v7
    v_lshlrev_b32 v6, 16, v97
    v_and_b32 v7, 0xffff0000, v97
    v_lshlrev_b32 v8, 16, v25
    v_and_b32 v9, 0xffff0000, v25
    v_add_f32 v6, v6, v8
    v_add_f32 v7, v7, v9
    v_cvt_pk_bf16_f32 v97, v6, v7
    v_add_u32 v4, 65536, v3
    buffer_store_dwordx2 v[96:97], v4, s[40:43], 0 offen
    v_cvt_pk_bf16_f32 v104, v104, v105
    v_cvt_pk_bf16_f32 v105, v106, v107
    v_lshlrev_b32 v6, 16, v104
    v_and_b32 v7, 0xffff0000, v104
    v_lshlrev_b32 v8, 16, v28
    v_and_b32 v9, 0xffff0000, v28
    v_add_f32 v6, v6, v8
    v_add_f32 v7, v7, v9
    v_cvt_pk_bf16_f32 v104, v6, v7
    v_lshlrev_b32 v6, 16, v105
    v_and_b32 v7, 0xffff0000, v105
    v_lshlrev_b32 v8, 16, v29
    v_and_b32 v9, 0xffff0000, v29
    v_add_f32 v6, v6, v8
    v_add_f32 v7, v7, v9
    v_cvt_pk_bf16_f32 v105, v6, v7
    v_add_u32 v4, 98304, v3
    buffer_store_dwordx2 v[104:105], v4, s[40:43], 0 offen
    s_mul_i32 s25, s21, 128
    s_mul_i32 s26, s24, 64
    s_add_u32 s25, s25, s26
    s_add_u32 s25, s25, 32
    v_add_u32 v3, s25, v1
    v_cvt_pk_bf16_f32 v84, v84, v85
    v_cvt_pk_bf16_f32 v85, v86, v87
    v_lshlrev_b32 v6, 16, v84
    v_and_b32 v7, 0xffff0000, v84
    v_lshlrev_b32 v8, 16, v18
    v_and_b32 v9, 0xffff0000, v18
    v_add_f32 v6, v6, v8
    v_add_f32 v7, v7, v9
    v_cvt_pk_bf16_f32 v84, v6, v7
    v_lshlrev_b32 v6, 16, v85
    v_and_b32 v7, 0xffff0000, v85
    v_lshlrev_b32 v8, 16, v19
    v_and_b32 v9, 0xffff0000, v19
    v_add_f32 v6, v6, v8
    v_add_f32 v7, v7, v9
    v_cvt_pk_bf16_f32 v85, v6, v7
    v_add_u32 v4, 0, v3
    buffer_store_dwordx2 v[84:85], v4, s[40:43], 0 offen
    v_cvt_pk_bf16_f32 v92, v92, v93
    v_cvt_pk_bf16_f32 v93, v94, v95
    v_lshlrev_b32 v6, 16, v92
    v_and_b32 v7, 0xffff0000, v92
    v_lshlrev_b32 v8, 16, v22
    v_and_b32 v9, 0xffff0000, v22
    v_add_f32 v6, v6, v8
    v_add_f32 v7, v7, v9
    v_cvt_pk_bf16_f32 v92, v6, v7
    v_lshlrev_b32 v6, 16, v93
    v_and_b32 v7, 0xffff0000, v93
    v_lshlrev_b32 v8, 16, v23
    v_and_b32 v9, 0xffff0000, v23
    v_add_f32 v6, v6, v8
    v_add_f32 v7, v7, v9
    v_cvt_pk_bf16_f32 v93, v6, v7
    v_add_u32 v4, 32768, v3
    buffer_store_dwordx2 v[92:93], v4, s[40:43], 0 offen
    v_cvt_pk_bf16_f32 v100, v100, v101
    v_cvt_pk_bf16_f32 v101, v102, v103
    v_lshlrev_b32 v6, 16, v100
    v_and_b32 v7, 0xffff0000, v100
    v_lshlrev_b32 v8, 16, v26
    v_and_b32 v9, 0xffff0000, v26
    v_add_f32 v6, v6, v8
    v_add_f32 v7, v7, v9
    v_cvt_pk_bf16_f32 v100, v6, v7
    v_lshlrev_b32 v6, 16, v101
    v_and_b32 v7, 0xffff0000, v101
    v_lshlrev_b32 v8, 16, v27
    v_and_b32 v9, 0xffff0000, v27
    v_add_f32 v6, v6, v8
    v_add_f32 v7, v7, v9
    v_cvt_pk_bf16_f32 v101, v6, v7
    v_add_u32 v4, 65536, v3
    buffer_store_dwordx2 v[100:101], v4, s[40:43], 0 offen
    v_cvt_pk_bf16_f32 v108, v108, v109
    v_cvt_pk_bf16_f32 v109, v110, v111
    v_lshlrev_b32 v6, 16, v108
    v_and_b32 v7, 0xffff0000, v108
    v_lshlrev_b32 v8, 16, v30
    v_and_b32 v9, 0xffff0000, v30
    v_add_f32 v6, v6, v8
    v_add_f32 v7, v7, v9
    v_cvt_pk_bf16_f32 v108, v6, v7
    v_lshlrev_b32 v6, 16, v109
    v_and_b32 v7, 0xffff0000, v109
    v_lshlrev_b32 v8, 16, v31
    v_and_b32 v9, 0xffff0000, v31
    v_add_f32 v6, v6, v8
    v_add_f32 v7, v7, v9
    v_cvt_pk_bf16_f32 v109, v6, v7
    v_add_u32 v4, 98304, v3
    buffer_store_dwordx2 v[108:109], v4, s[40:43], 0 offen
g4_kernel_end:
    s_endpgm
.section .rodata,"a"
.p2align 6
.amdhsa_kernel g1_kernel
  .amdhsa_next_free_vgpr 240
  .amdhsa_next_free_sgpr 100
  .amdhsa_accum_offset 240
  .amdhsa_group_segment_fixed_size 0
  .amdhsa_kernarg_size 80
  .amdhsa_user_sgpr_count 2
  .amdhsa_user_sgpr_kernarg_segment_ptr 1
  .amdhsa_system_sgpr_workgroup_id_x 1
.end_amdhsa_kernel
.p2align 6
.amdhsa_kernel attn_kernel
  .amdhsa_next_free_vgpr 216
  .amdhsa_next_free_sgpr 100
  .amdhsa_accum_offset 216
  .amdhsa_group_segment_fixed_size 0
  .amdhsa_kernarg_size 80
  .amdhsa_user_sgpr_count 2
  .amdhsa_user_sgpr_kernarg_segment_ptr 1
  .amdhsa_system_sgpr_workgroup_id_x 1
.end_amdhsa_kernel
.p2align 6
.amdhsa_kernel g2_kernel
  .amdhsa_next_free_vgpr 112
  .amdhsa_next_free_sgpr 100
  .amdhsa_accum_offset 112
  .amdhsa_group_segment_fixed_size 0
  .amdhsa_kernarg_size 80
  .amdhsa_user_sgpr_count 2
  .amdhsa_user_sgpr_kernarg_segment_ptr 1
  .amdhsa_system_sgpr_workgroup_id_x 1
.end_amdhsa_kernel
.p2align 6
.amdhsa_kernel g3_kernel
  .amdhsa_next_free_vgpr 256
  .amdhsa_next_free_sgpr 100
  .amdhsa_accum_offset 256
  .amdhsa_group_segment_fixed_size 0
  .amdhsa_kernarg_size 80
  .amdhsa_user_sgpr_count 2
  .amdhsa_user_sgpr_kernarg_segment_ptr 1
  .amdhsa_system_sgpr_workgroup_id_x 1
.end_amdhsa_kernel
.p2align 6
.amdhsa_kernel g4_kernel
  .amdhsa_next_free_vgpr 112
  .amdhsa_next_free_sgpr 100
  .amdhsa_accum_offset 112
  .amdhsa_group_segment_fixed_size 0
  .amdhsa_kernarg_size 80
  .amdhsa_user_sgpr_count 2
  .amdhsa_user_sgpr_kernarg_segment_ptr 1
  .amdhsa_system_sgpr_workgroup_id_x 1
.end_amdhsa_kernel
```
